```python
import torch

def _softmax(x, axis=-1):
    return torch.softmax(x, dim=axis)
def _gelu(x):
    return torch.nn.functional.gelu(x, approximate="tanh")
def _silu(x):
    return torch.nn.functional.silu(x)
def _sigmoid(x):
    return torch.sigmoid(x)
def _layernorm(x, axis=-1, eps=1e-5):
    m = x.mean(dim=axis, keepdim=True)
    v = x.var(dim=axis, keepdim=True, unbiased=False)
    return (x - m) / torch.sqrt(v + eps)
def _scatter_add(tgt, idx, src, axis=0):
    return tgt.clone().index_add_(axis, idx, src)
def _segment_sum(src, seg, n):
    out = torch.zeros((n,) + src.shape[1:], dtype=src.dtype)
    return out.index_add_(0, seg, src)
def _pad(x, pw):
    flat = tuple(v for pair in reversed(pw) for v in pair)
    return torch.nn.functional.pad(x, flat)

kernel_name = 'recurrent_scan__sliding_local_dilated__glu_gated_swiglu__prompt'

def setup_inputs():

    _w = (lambda a: (lambda t: t.to(torch.bfloat16) if t.is_floating_point() else t)(torch.as_tensor(a)))
    def _A_setup():
        B, S, D = 1, 2048, 1024
        return {
            "x": _w((lambda *s: torch.randn(*s, dtype=torch.bfloat16) * 0.05)(B, S, D)),
            "wqkv": _w((lambda *s: torch.randn(*s, dtype=torch.bfloat16) * 0.2)(D, 3 * D)),
            "wo": _w((lambda *s: torch.randn(*s, dtype=torch.bfloat16) * 0.2)(D, D)),
        }
    _A_in = _A_setup()

    def _B_setup():
        B, S, D, F = 1, 2048, 1024, 3584
        return {
            "x": _w((lambda *s: torch.randn(*s, dtype=torch.bfloat16) * 0.05)(B, S, D)),
            "w1": _w((lambda *s: torch.randn(*s, dtype=torch.bfloat16) * 0.1)(D, F) * (2.0 / D) ** 0.5),
            "w3": _w((lambda *s: torch.randn(*s, dtype=torch.bfloat16) * 0.1)(D, F) * (2.0 / D) ** 0.5),
            "w2": _w((lambda *s: torch.randn(*s, dtype=torch.bfloat16) * 0.1)(F, D) * (2.0 / F) ** 0.5),
        }
    _B_in = _B_setup()

    return {
        "A_x": _A_in["x"],
        "A_wqkv": _A_in["wqkv"],
        "A_wo": _A_in["wo"],
        "B_x": _B_in["x"],
        "B_w1": _B_in["w1"],
        "B_w3": _B_in["w3"],
        "B_w2": _B_in["w2"],
    }

def reference(A_x, A_wqkv, A_wo, B_x, B_w1, B_w3, B_w2):
    def _A_ref(x, wqkv, wo):
        B, S, D = x.shape
        H = 32; Dh = D // H
        W, dil = 8, 2
        qkv = (lambda x, *d: x.permute(*d))((x @ wqkv).reshape(B, S, 3, H, Dh), 2, 0, 3, 1, 4)
        q, k, v = qkv[0], qkv[1], qkv[2]
        scale = Dh ** -0.5
        pos = torch.arange(S)
        off = torch.arange(W) * dil
        idx = pos[:, None] - off[None, :]
        mask = idx >= 0
        idx_c = torch.where(mask, idx, 0).reshape(-1)
        kg = k[:, :, idx_c, :].reshape(B, H, S, W, Dh)
        vg = v[:, :, idx_c, :].reshape(B, H, S, W, Dh)
        logits = torch.einsum("bhsd,bhswd->bhsw", q, kg) * scale
        logits = torch.where(mask[None, None, :, :], logits, -1e9)
        attn = _softmax(logits, axis=-1)
        o = torch.einsum("bhsw,bhswd->bhsd", attn, vg)
        return (lambda x, *d: x.permute(*d))(o, 0, 2, 1, 3).reshape(B, S, D) @ wo

    def _B_ref(x, w1, w3, w2):
        gate = torch.einsum("bsd,df->bsf", x, w1)
        up = torch.einsum("bsd,df->bsf", x, w3)
        h = _silu(gate) * up
        out = torch.einsum("bsf,fd->bsd", h, w2)
        return out

    x = A_x
    xn = _layernorm(x, axis=-1)
    s = _A_ref(xn, A_wqkv, A_wo)
    g = _silu(_B_ref(xn, B_w1, B_w3, B_w2))
    return x + s * g
```

```asm
; @launch kernel=ln_kernel grid=(512,1,1) block=(256,1,1) lds=0
; @launch kernel=g1_kernel grid=(256,1,1) block=(512,1,1) lds=147456
; @launch kernel=attn_kernel grid=(1024,1,1) block=(256,1,1) lds=0
; @launch kernel=g2_kernel grid=(256,1,1) block=(512,1,1) lds=147456
.amdgcn_target "amdgcn-amd-amdhsa--gfx950"
.text
.globl ln_kernel
.p2align 8
.type ln_kernel,@function
ln_kernel:
    s_cmp_ge_u32 s2, 512
    s_cbranch_scc1 ln_done
    s_load_dwordx2 s[4:5], s[0:1], 0
    s_load_dwordx2 s[6:7], s[0:1], 72
    s_waitcnt lgkmcnt(0)
    s_mov_b32 s8, s4
    s_mov_b32 s9, s5
    s_mov_b32 s10, 0x400000
    s_mov_b32 s11, 0x00020000
    s_mov_b32 s12, s6
    s_mov_b32 s13, s7
    s_mov_b32 s14, 0x400000
    s_mov_b32 s15, 0x00020000
    v_lshrrev_b32 v1, 6, v0
    v_and_b32 v2, 63, v0
    s_lshl_b32 s16, s2, 2
    v_add_u32 v1, s16, v1
    v_lshlrev_b32 v1, 11, v1
    v_lshlrev_b32 v3, 4, v2
    v_add_u32 v1, v1, v3
    buffer_load_dwordx4 v[4:7], v1, s[8:11], 0 offen
    buffer_load_dwordx4 v[8:11], v1, s[8:11], 0 offen offset:1024
    s_waitcnt vmcnt(0)
    v_lshlrev_b32 v12, 16, v4
    v_and_b32 v13, 0xffff0000, v4
    v_lshlrev_b32 v14, 16, v5
    v_and_b32 v15, 0xffff0000, v5
    v_lshlrev_b32 v16, 16, v6
    v_and_b32 v17, 0xffff0000, v6
    v_lshlrev_b32 v18, 16, v7
    v_and_b32 v19, 0xffff0000, v7
    v_lshlrev_b32 v20, 16, v8
    v_and_b32 v21, 0xffff0000, v8
    v_lshlrev_b32 v22, 16, v9
    v_and_b32 v23, 0xffff0000, v9
    v_lshlrev_b32 v24, 16, v10
    v_and_b32 v25, 0xffff0000, v10
    v_lshlrev_b32 v26, 16, v11
    v_and_b32 v27, 0xffff0000, v11
    v_add_f32 v28, v12, v13
    v_add_f32 v28, v28, v14
    v_add_f32 v28, v28, v15
    v_add_f32 v28, v28, v16
    v_add_f32 v28, v28, v17
    v_add_f32 v28, v28, v18
    v_add_f32 v28, v28, v19
    v_add_f32 v28, v28, v20
    v_add_f32 v28, v28, v21
    v_add_f32 v28, v28, v22
    v_add_f32 v28, v28, v23
    v_add_f32 v28, v28, v24
    v_add_f32 v28, v28, v25
    v_add_f32 v28, v28, v26
    v_add_f32 v28, v28, v27
    ds_swizzle_b32 v29, v28 offset:0x041F
    s_waitcnt lgkmcnt(0)
    v_add_f32 v28, v28, v29
    ds_swizzle_b32 v29, v28 offset:0x081F
    s_waitcnt lgkmcnt(0)
    v_add_f32 v28, v28, v29
    ds_swizzle_b32 v29, v28 offset:0x101F
    s_waitcnt lgkmcnt(0)
    v_add_f32 v28, v28, v29
    ds_swizzle_b32 v29, v28 offset:0x201F
    s_waitcnt lgkmcnt(0)
    v_add_f32 v28, v28, v29
    ds_swizzle_b32 v29, v28 offset:0x401F
    s_waitcnt lgkmcnt(0)
    v_add_f32 v28, v28, v29
    s_nop 0
    v_readlane_b32 s20, v28, 0
    v_readlane_b32 s21, v28, 32
    s_nop 1
    v_mov_b32 v28, s20
    v_add_f32 v28, s21, v28
    v_mul_f32 v28, 0x3a800000, v28
    v_sub_f32 v30, v12, v28
    v_mul_f32 v31, v30, v30
    v_sub_f32 v30, v13, v28
    v_fmac_f32 v31, v30, v30
    v_sub_f32 v30, v14, v28
    v_fmac_f32 v31, v30, v30
    v_sub_f32 v30, v15, v28
    v_fmac_f32 v31, v30, v30
    v_sub_f32 v30, v16, v28
    v_fmac_f32 v31, v30, v30
    v_sub_f32 v30, v17, v28
    v_fmac_f32 v31, v30, v30
    v_sub_f32 v30, v18, v28
    v_fmac_f32 v31, v30, v30
    v_sub_f32 v30, v19, v28
    v_fmac_f32 v31, v30, v30
    v_sub_f32 v30, v20, v28
    v_fmac_f32 v31, v30, v30
    v_sub_f32 v30, v21, v28
    v_fmac_f32 v31, v30, v30
    v_sub_f32 v30, v22, v28
    v_fmac_f32 v31, v30, v30
    v_sub_f32 v30, v23, v28
    v_fmac_f32 v31, v30, v30
    v_sub_f32 v30, v24, v28
    v_fmac_f32 v31, v30, v30
    v_sub_f32 v30, v25, v28
    v_fmac_f32 v31, v30, v30
    v_sub_f32 v30, v26, v28
    v_fmac_f32 v31, v30, v30
    v_sub_f32 v30, v27, v28
    v_fmac_f32 v31, v30, v30
    ds_swizzle_b32 v29, v31 offset:0x041F
    s_waitcnt lgkmcnt(0)
    v_add_f32 v31, v31, v29
    ds_swizzle_b32 v29, v31 offset:0x081F
    s_waitcnt lgkmcnt(0)
    v_add_f32 v31, v31, v29
    ds_swizzle_b32 v29, v31 offset:0x101F
    s_waitcnt lgkmcnt(0)
    v_add_f32 v31, v31, v29
    ds_swizzle_b32 v29, v31 offset:0x201F
    s_waitcnt lgkmcnt(0)
    v_add_f32 v31, v31, v29
    ds_swizzle_b32 v29, v31 offset:0x401F
    s_waitcnt lgkmcnt(0)
    v_add_f32 v31, v31, v29
    s_nop 0
    v_readlane_b32 s22, v31, 0
    v_readlane_b32 s23, v31, 32
    s_nop 1
    v_mov_b32 v31, s22
    v_add_f32 v31, s23, v31
    v_mul_f32 v31, 0x3a800000, v31
    v_cvt_pk_bf16_f32 v32, v28, v31
    s_nop 0
    v_lshlrev_b32 v33, 16, v32
    v_and_b32 v34, 0xffff0000, v32
    v_add_f32 v34, 0x3727c5ac, v34
    v_cvt_pk_bf16_f32 v34, v34, v34
    s_nop 0
    v_and_b32 v34, 0xffff0000, v34
    v_sqrt_f32 v34, v34
    s_nop 0
    v_cvt_pk_bf16_f32 v34, v34, v34
    s_nop 0
    v_and_b32 v34, 0xffff0000, v34
    v_rcp_f32 v35, v34
    s_nop 0
    v_fma_f32 v36, -v34, v35, 2.0
    v_mul_f32 v35, v35, v36
    v_sub_f32 v36, v12, v33
    v_sub_f32 v37, v13, v33
    v_cvt_pk_bf16_f32 v38, v36, v37
    s_nop 0
    v_lshlrev_b32 v36, 16, v38
    v_and_b32 v37, 0xffff0000, v38
    v_mul_f32 v36, v36, v35
    v_mul_f32 v37, v37, v35
    v_cvt_pk_bf16_f32 v40, v36, v37
    v_sub_f32 v36, v14, v33
    v_sub_f32 v37, v15, v33
    v_cvt_pk_bf16_f32 v38, v36, v37
    s_nop 0
    v_lshlrev_b32 v36, 16, v38
    v_and_b32 v37, 0xffff0000, v38
    v_mul_f32 v36, v36, v35
    v_mul_f32 v37, v37, v35
    v_cvt_pk_bf16_f32 v41, v36, v37
    v_sub_f32 v36, v16, v33
    v_sub_f32 v37, v17, v33
    v_cvt_pk_bf16_f32 v38, v36, v37
    s_nop 0
    v_lshlrev_b32 v36, 16, v38
    v_and_b32 v37, 0xffff0000, v38
    v_mul_f32 v36, v36, v35
    v_mul_f32 v37, v37, v35
    v_cvt_pk_bf16_f32 v42, v36, v37
    v_sub_f32 v36, v18, v33
    v_sub_f32 v37, v19, v33
    v_cvt_pk_bf16_f32 v38, v36, v37
    s_nop 0
    v_lshlrev_b32 v36, 16, v38
    v_and_b32 v37, 0xffff0000, v38
    v_mul_f32 v36, v36, v35
    v_mul_f32 v37, v37, v35
    v_cvt_pk_bf16_f32 v43, v36, v37
    v_sub_f32 v36, v20, v33
    v_sub_f32 v37, v21, v33
    v_cvt_pk_bf16_f32 v38, v36, v37
    s_nop 0
    v_lshlrev_b32 v36, 16, v38
    v_and_b32 v37, 0xffff0000, v38
    v_mul_f32 v36, v36, v35
    v_mul_f32 v37, v37, v35
    v_cvt_pk_bf16_f32 v44, v36, v37
    v_sub_f32 v36, v22, v33
    v_sub_f32 v37, v23, v33
    v_cvt_pk_bf16_f32 v38, v36, v37
    s_nop 0
    v_lshlrev_b32 v36, 16, v38
    v_and_b32 v37, 0xffff0000, v38
    v_mul_f32 v36, v36, v35
    v_mul_f32 v37, v37, v35
    v_cvt_pk_bf16_f32 v45, v36, v37
    v_sub_f32 v36, v24, v33
    v_sub_f32 v37, v25, v33
    v_cvt_pk_bf16_f32 v38, v36, v37
    s_nop 0
    v_lshlrev_b32 v36, 16, v38
    v_and_b32 v37, 0xffff0000, v38
    v_mul_f32 v36, v36, v35
    v_mul_f32 v37, v37, v35
    v_cvt_pk_bf16_f32 v46, v36, v37
    v_sub_f32 v36, v26, v33
    v_sub_f32 v37, v27, v33
    v_cvt_pk_bf16_f32 v38, v36, v37
    s_nop 0
    v_lshlrev_b32 v36, 16, v38
    v_and_b32 v37, 0xffff0000, v38
    v_mul_f32 v36, v36, v35
    v_mul_f32 v37, v37, v35
    v_cvt_pk_bf16_f32 v47, v36, v37
    s_nop 0
    buffer_store_dwordx4 v[40:43], v1, s[12:15], 0 offen
    buffer_store_dwordx4 v[44:47], v1, s[12:15], 0 offen offset:1024
ln_done:
    s_endpgm
.globl g1_kernel
.p2align 8
.type g1_kernel,@function
g1_kernel:
    s_cmp_ge_u32 s2, 256
    s_cbranch_scc1 g1_done
    s_load_dwordx2 s[44:45], s[0:1], 72
    s_load_dwordx2 s[46:47], s[0:1], 8
    s_load_dwordx2 s[48:49], s[0:1], 32
    s_load_dwordx2 s[50:51], s[0:1], 40
    s_and_b32 s52, s2, 7
    s_lshr_b32 s53, s2, 3
    s_lshl_b32 s52, s52, 2
    s_and_b32 s54, s53, 3
    s_add_u32 s81, s52, s54
    s_lshr_b32 s53, s53, 2
    v_lshrrev_b32 v1, 6, v0
    v_and_b32 v15, 63, v0
    s_nop 1
    v_readfirstlane_b32 s26, v1
    s_nop 3
    s_lshr_b32 s27, s26, 1
    s_and_b32 s28, s26, 1
    s_lshl_b32 s80, s53, 8
    s_lshl_b32 s54, s27, 6
    s_add_u32 s80, s80, s54
    s_waitcnt lgkmcnt(0)
    s_mov_b32 s4, s44
    s_mov_b32 s5, s45
    s_mov_b32 s6, 0x400000
    s_mov_b32 s7, 0x00020000
    s_lshr_b32 s55, s26, 2
    s_lshr_b32 s56, s26, 1
    s_and_b32 s56, s56, 1
    s_mul_i32 s57, s81, 320
    s_mul_i32 s58, s56, 160
    s_add_u32 s57, s57, s58
    s_mul_i32 s58, s55, 80
    s_add_u32 s57, s57, s58
    s_mov_b32 s8, s46
    s_mov_b32 s9, s47
    s_mov_b32 s10, 0x600000
    s_mov_b32 s11, 0x00020000
    s_mov_b32 s12, s46
    s_mov_b32 s13, s47
    s_mov_b32 s14, 0x600000
    s_mov_b32 s15, 0x00020000
    s_mov_b32 s23, 393216
    s_mov_b32 s24, 458752
    s_mov_b32 s42, 0
    s_mov_b32 s59, 6144
    s_cmp_lt_u32 s81, 9
    s_cbranch_scc1 g1_srcdone
    s_cmp_eq_u32 s55, 0
    s_cselect_b32 s60, s48, s50
    s_cselect_b32 s61, s49, s51
    s_cmp_eq_u32 s81, 9
    s_cbranch_scc1 g1_mixed
    s_mov_b32 s8, s60
    s_mov_b32 s9, s61
    s_mov_b32 s10, 0x700000
    s_mov_b32 s11, 0x00020000
    s_sub_u32 s57, s81, 10
    s_mul_i32 s57, s57, 160
    s_add_u32 s57, s57, 64
    s_mul_i32 s58, s56, 80
    s_add_u32 s57, s57, s58
    s_mov_b32 s23, 458752
    s_mov_b32 s59, 7168
    s_branch g1_srcdone
g1_mixed:
    s_cmp_eq_u32 s56, 0
    s_cbranch_scc1 g1_srcdone
    s_mov_b32 s12, s60
    s_mov_b32 s13, s61
    s_mov_b32 s14, 0x700000
    s_mov_b32 s15, 0x00020000
    s_mov_b32 s42, 1
g1_srcdone:
    s_lshl_b32 s60, s53, 8
    s_lshl_b32 s61, s26, 5
    s_add_u32 s60, s60, s61
    v_lshrrev_b32 v16, 3, v15
    v_and_b32 v17, 7, v15
    v_add_u32 v18, 0, v16
    v_lshrrev_b32 v19, 1, v18
    v_and_b32 v19, 7, v19
    v_xor_b32 v19, v19, v17
    v_lshlrev_b32 v19, 4, v19
    v_add_u32 v18, s60, v18
    v_lshlrev_b32 v18, 11, v18
    v_add_u32 v6, v18, v19
    v_add_u32 v18, 8, v16
    v_lshrrev_b32 v19, 1, v18
    v_and_b32 v19, 7, v19
    v_xor_b32 v19, v19, v17
    v_lshlrev_b32 v19, 4, v19
    v_add_u32 v18, s60, v18
    v_lshlrev_b32 v18, 11, v18
    v_add_u32 v7, v18, v19
    v_add_u32 v18, 16, v16
    v_lshrrev_b32 v19, 1, v18
    v_and_b32 v19, 7, v19
    v_xor_b32 v19, v19, v17
    v_lshlrev_b32 v19, 4, v19
    v_add_u32 v18, s60, v18
    v_lshlrev_b32 v18, 11, v18
    v_add_u32 v8, v18, v19
    v_add_u32 v18, 24, v16
    v_lshrrev_b32 v19, 1, v18
    v_and_b32 v19, 7, v19
    v_xor_b32 v19, v19, v17
    v_lshlrev_b32 v19, 4, v19
    v_add_u32 v18, s60, v18
    v_lshlrev_b32 v18, 11, v18
    v_add_u32 v9, v18, v19
    s_lshl_b32 s29, s26, 12
    s_and_b32 s60, s26, 1
    s_mul_i32 s60, s60, 320
    v_add_u32 v18, s60, v15
    v_mul_u32_u24 v19, 205, v18
    v_lshrrev_b32 v19, 11, v19
    v_mul_u32_u24 v20, 10, v19
    v_sub_u32 v20, v18, v20
    v_and_b32 v21, 32, v19
    v_and_b32 v22, 15, v19
    v_lshrrev_b32 v22, 2, v22
    v_lshlrev_b32 v22, 3, v22
    v_add_u32 v21, v21, v22
    v_and_b32 v22, 16, v19
    v_lshrrev_b32 v22, 2, v22
    v_add_u32 v21, v21, v22
    v_and_b32 v22, 3, v19
    v_add_u32 v21, v21, v22
    v_mul_lo_u32 v22, v21, s59
    v_lshlrev_b32 v23, 3, v20
    v_add_u32 v23, s57, v23
    v_lshlrev_b32 v23, 1, v23
    v_add_u32 v10, v22, v23
    v_cmp_gt_u32 vcc, 2, v20
    s_mov_b32 s61, 7168
    v_mul_lo_u32 v22, v21, s61
    v_lshlrev_b32 v23, 4, v20
    v_subrev_u32 v23, 32, v23
    v_add_u32 v22, v22, v23
    s_lshl_b32 s62, s55, 4
    s_add_u32 s62, s62, 3040
    v_mul_u32_u24 v24, 6144, v21
    v_lshlrev_b32 v23, 3, v20
    v_add_u32 v23, s62, v23
    v_lshlrev_b32 v23, 1, v23
    v_add_u32 v24, v24, v23
    v_cndmask_b32 v24, v22, v24, vcc
    s_cmp_eq_u32 s42, 0
    s_cselect_b64 s[32:33], -1, vcc
    s_cselect_b64 s[64:65], -1, 0
    s_nop 1
    v_cndmask_b32 v10, v24, v10, s[64:65]
    v_add_u32 v18, s60, v15
    v_add_u32 v18, 64, v18
    v_mul_u32_u24 v19, 205, v18
    v_lshrrev_b32 v19, 11, v19
    v_mul_u32_u24 v20, 10, v19
    v_sub_u32 v20, v18, v20
    v_and_b32 v21, 32, v19
    v_and_b32 v22, 15, v19
    v_lshrrev_b32 v22, 2, v22
    v_lshlrev_b32 v22, 3, v22
    v_add_u32 v21, v21, v22
    v_and_b32 v22, 16, v19
    v_lshrrev_b32 v22, 2, v22
    v_add_u32 v21, v21, v22
    v_and_b32 v22, 3, v19
    v_add_u32 v21, v21, v22
    v_mul_lo_u32 v22, v21, s59
    v_lshlrev_b32 v23, 3, v20
    v_add_u32 v23, s57, v23
    v_lshlrev_b32 v23, 1, v23
    v_add_u32 v11, v22, v23
    v_cmp_gt_u32 vcc, 2, v20
    s_mov_b32 s61, 7168
    v_mul_lo_u32 v22, v21, s61
    v_lshlrev_b32 v23, 4, v20
    v_subrev_u32 v23, 32, v23
    v_add_u32 v22, v22, v23
    s_lshl_b32 s62, s55, 4
    s_add_u32 s62, s62, 3040
    v_mul_u32_u24 v24, 6144, v21
    v_lshlrev_b32 v23, 3, v20
    v_add_u32 v23, s62, v23
    v_lshlrev_b32 v23, 1, v23
    v_add_u32 v24, v24, v23
    v_cndmask_b32 v24, v22, v24, vcc
    s_cmp_eq_u32 s42, 0
    s_cselect_b64 s[34:35], -1, vcc
    s_cselect_b64 s[64:65], -1, 0
    s_nop 1
    v_cndmask_b32 v11, v24, v11, s[64:65]
    v_add_u32 v18, s60, v15
    v_add_u32 v18, 128, v18
    v_mul_u32_u24 v19, 205, v18
    v_lshrrev_b32 v19, 11, v19
    v_mul_u32_u24 v20, 10, v19
    v_sub_u32 v20, v18, v20
    v_and_b32 v21, 32, v19
    v_and_b32 v22, 15, v19
    v_lshrrev_b32 v22, 2, v22
    v_lshlrev_b32 v22, 3, v22
    v_add_u32 v21, v21, v22
    v_and_b32 v22, 16, v19
    v_lshrrev_b32 v22, 2, v22
    v_add_u32 v21, v21, v22
    v_and_b32 v22, 3, v19
    v_add_u32 v21, v21, v22
    v_mul_lo_u32 v22, v21, s59
    v_lshlrev_b32 v23, 3, v20
    v_add_u32 v23, s57, v23
    v_lshlrev_b32 v23, 1, v23
    v_add_u32 v12, v22, v23
    v_cmp_gt_u32 vcc, 2, v20
    s_mov_b32 s61, 7168
    v_mul_lo_u32 v22, v21, s61
    v_lshlrev_b32 v23, 4, v20
    v_subrev_u32 v23, 32, v23
    v_add_u32 v22, v22, v23
    s_lshl_b32 s62, s55, 4
    s_add_u32 s62, s62, 3040
    v_mul_u32_u24 v24, 6144, v21
    v_lshlrev_b32 v23, 3, v20
    v_add_u32 v23, s62, v23
    v_lshlrev_b32 v23, 1, v23
    v_add_u32 v24, v24, v23
    v_cndmask_b32 v24, v22, v24, vcc
    s_cmp_eq_u32 s42, 0
    s_cselect_b64 s[36:37], -1, vcc
    s_cselect_b64 s[64:65], -1, 0
    s_nop 1
    v_cndmask_b32 v12, v24, v12, s[64:65]
    v_add_u32 v18, s60, v15
    v_add_u32 v18, 192, v18
    v_mul_u32_u24 v19, 205, v18
    v_lshrrev_b32 v19, 11, v19
    v_mul_u32_u24 v20, 10, v19
    v_sub_u32 v20, v18, v20
    v_and_b32 v21, 32, v19
    v_and_b32 v22, 15, v19
    v_lshrrev_b32 v22, 2, v22
    v_lshlrev_b32 v22, 3, v22
    v_add_u32 v21, v21, v22
    v_and_b32 v22, 16, v19
    v_lshrrev_b32 v22, 2, v22
    v_add_u32 v21, v21, v22
    v_and_b32 v22, 3, v19
    v_add_u32 v21, v21, v22
    v_mul_lo_u32 v22, v21, s59
    v_lshlrev_b32 v23, 3, v20
    v_add_u32 v23, s57, v23
    v_lshlrev_b32 v23, 1, v23
    v_add_u32 v13, v22, v23
    v_cmp_gt_u32 vcc, 2, v20
    s_mov_b32 s61, 7168
    v_mul_lo_u32 v22, v21, s61
    v_lshlrev_b32 v23, 4, v20
    v_subrev_u32 v23, 32, v23
    v_add_u32 v22, v22, v23
    s_lshl_b32 s62, s55, 4
    s_add_u32 s62, s62, 3040
    v_mul_u32_u24 v24, 6144, v21
    v_lshlrev_b32 v23, 3, v20
    v_add_u32 v23, s62, v23
    v_lshlrev_b32 v23, 1, v23
    v_add_u32 v24, v24, v23
    v_cndmask_b32 v24, v22, v24, vcc
    s_cmp_eq_u32 s42, 0
    s_cselect_b64 s[38:39], -1, vcc
    s_cselect_b64 s[64:65], -1, 0
    s_nop 1
    v_cndmask_b32 v13, v24, v13, s[64:65]
    v_add_u32 v18, s60, v15
    v_add_u32 v18, 256, v18
    v_mul_u32_u24 v19, 205, v18
    v_lshrrev_b32 v19, 11, v19
    v_mul_u32_u24 v20, 10, v19
    v_sub_u32 v20, v18, v20
    v_and_b32 v21, 32, v19
    v_and_b32 v22, 15, v19
    v_lshrrev_b32 v22, 2, v22
    v_lshlrev_b32 v22, 3, v22
    v_add_u32 v21, v21, v22
    v_and_b32 v22, 16, v19
    v_lshrrev_b32 v22, 2, v22
    v_add_u32 v21, v21, v22
    v_and_b32 v22, 3, v19
    v_add_u32 v21, v21, v22
    v_mul_lo_u32 v22, v21, s59
    v_lshlrev_b32 v23, 3, v20
    v_add_u32 v23, s57, v23
    v_lshlrev_b32 v23, 1, v23
    v_add_u32 v14, v22, v23
    v_cmp_gt_u32 vcc, 2, v20
    s_mov_b32 s61, 7168
    v_mul_lo_u32 v22, v21, s61
    v_lshlrev_b32 v23, 4, v20
    v_subrev_u32 v23, 32, v23
    v_add_u32 v22, v22, v23
    s_lshl_b32 s62, s55, 4
    s_add_u32 s62, s62, 3040
    v_mul_u32_u24 v24, 6144, v21
    v_lshlrev_b32 v23, 3, v20
    v_add_u32 v23, s62, v23
    v_lshlrev_b32 v23, 1, v23
    v_add_u32 v24, v24, v23
    v_cndmask_b32 v24, v22, v24, vcc
    s_cmp_eq_u32 s42, 0
    s_cselect_b64 s[40:41], -1, vcc
    s_cselect_b64 s[64:65], -1, 0
    s_nop 1
    v_cndmask_b32 v14, v24, v14, s[64:65]
    s_lshr_b32 s60, s26, 1
    s_mul_i32 s30, s60, 10240
    s_and_b32 s60, s26, 1
    s_mul_i32 s60, s60, 5120
    s_add_u32 s30, s30, s60
    s_add_u32 s30, s30, 65536
    v_and_b32 v16, 15, v15
    v_lshrrev_b32 v17, 4, v15
    v_lshrrev_b32 v18, 1, v16
    v_xor_b32 v18, v18, v17
    v_lshlrev_b32 v18, 4, v18
    v_lshlrev_b32 v19, 7, v16
    v_add_u32 v18, v18, v19
    s_lshl_b32 s60, s27, 13
    v_add_u32 v2, s60, v18
    v_xor_b32 v3, 64, v2
    v_lshrrev_b32 v16, 4, v15
    v_lshlrev_b32 v16, 2, v16
    v_and_b32 v17, 15, v15
    v_lshrrev_b32 v17, 2, v17
    v_add_u32 v16, v16, v17
    v_mul_u32_u24 v16, 160, v16
    v_and_b32 v17, 3, v15
    v_lshlrev_b32 v17, 3, v17
    v_add_u32 v16, v16, v17
    s_mul_i32 s60, s28, 10240
    s_add_u32 s60, s60, 65536
    v_add_u32 v4, s60, v16
    v_add_u32 v5, 40960, v4
    s_mov_b32 s20, 0
    s_mov_b32 s21, 0
    s_mov_b32 s22, 0
    v_mov_b32 v96, 0
    v_mov_b32 v97, 0
    v_mov_b32 v98, 0
    v_mov_b32 v99, 0
    v_mov_b32 v100, 0
    v_mov_b32 v101, 0
    v_mov_b32 v102, 0
    v_mov_b32 v103, 0
    v_mov_b32 v104, 0
    v_mov_b32 v105, 0
    v_mov_b32 v106, 0
    v_mov_b32 v107, 0
    v_mov_b32 v108, 0
    v_mov_b32 v109, 0
    v_mov_b32 v110, 0
    v_mov_b32 v111, 0
    v_mov_b32 v112, 0
    v_mov_b32 v113, 0
    v_mov_b32 v114, 0
    v_mov_b32 v115, 0
    v_mov_b32 v116, 0
    v_mov_b32 v117, 0
    v_mov_b32 v118, 0
    v_mov_b32 v119, 0
    v_mov_b32 v120, 0
    v_mov_b32 v121, 0
    v_mov_b32 v122, 0
    v_mov_b32 v123, 0
    v_mov_b32 v124, 0
    v_mov_b32 v125, 0
    v_mov_b32 v126, 0
    v_mov_b32 v127, 0
    v_mov_b32 v128, 0
    v_mov_b32 v129, 0
    v_mov_b32 v130, 0
    v_mov_b32 v131, 0
    v_mov_b32 v132, 0
    v_mov_b32 v133, 0
    v_mov_b32 v134, 0
    v_mov_b32 v135, 0
    v_mov_b32 v136, 0
    v_mov_b32 v137, 0
    v_mov_b32 v138, 0
    v_mov_b32 v139, 0
    v_mov_b32 v140, 0
    v_mov_b32 v141, 0
    v_mov_b32 v142, 0
    v_mov_b32 v143, 0
    v_mov_b32 v144, 0
    v_mov_b32 v145, 0
    v_mov_b32 v146, 0
    v_mov_b32 v147, 0
    v_mov_b32 v148, 0
    v_mov_b32 v149, 0
    v_mov_b32 v150, 0
    v_mov_b32 v151, 0
    v_mov_b32 v152, 0
    v_mov_b32 v153, 0
    v_mov_b32 v154, 0
    v_mov_b32 v155, 0
    v_mov_b32 v156, 0
    v_mov_b32 v157, 0
    v_mov_b32 v158, 0
    v_mov_b32 v159, 0
    v_mov_b32 v160, 0
    v_mov_b32 v161, 0
    v_mov_b32 v162, 0
    v_mov_b32 v163, 0
    v_mov_b32 v164, 0
    v_mov_b32 v165, 0
    v_mov_b32 v166, 0
    v_mov_b32 v167, 0
    v_mov_b32 v168, 0
    v_mov_b32 v169, 0
    v_mov_b32 v170, 0
    v_mov_b32 v171, 0
    v_mov_b32 v172, 0
    v_mov_b32 v173, 0
    v_mov_b32 v174, 0
    v_mov_b32 v175, 0
    v_mov_b32 v176, 0
    v_mov_b32 v177, 0
    v_mov_b32 v178, 0
    v_mov_b32 v179, 0
    v_mov_b32 v180, 0
    v_mov_b32 v181, 0
    v_mov_b32 v182, 0
    v_mov_b32 v183, 0
    v_mov_b32 v184, 0
    v_mov_b32 v185, 0
    v_mov_b32 v186, 0
    v_mov_b32 v187, 0
    v_mov_b32 v188, 0
    v_mov_b32 v189, 0
    v_mov_b32 v190, 0
    v_mov_b32 v191, 0
    v_mov_b32 v192, 0
    v_mov_b32 v193, 0
    v_mov_b32 v194, 0
    v_mov_b32 v195, 0
    v_mov_b32 v196, 0
    v_mov_b32 v197, 0
    v_mov_b32 v198, 0
    v_mov_b32 v199, 0
    v_mov_b32 v200, 0
    v_mov_b32 v201, 0
    v_mov_b32 v202, 0
    v_mov_b32 v203, 0
    v_mov_b32 v204, 0
    v_mov_b32 v205, 0
    v_mov_b32 v206, 0
    v_mov_b32 v207, 0
    v_mov_b32 v208, 0
    v_mov_b32 v209, 0
    v_mov_b32 v210, 0
    v_mov_b32 v211, 0
    v_mov_b32 v212, 0
    v_mov_b32 v213, 0
    v_mov_b32 v214, 0
    v_mov_b32 v215, 0
    v_mov_b32 v216, 0
    v_mov_b32 v217, 0
    v_mov_b32 v218, 0
    v_mov_b32 v219, 0
    v_mov_b32 v220, 0
    v_mov_b32 v221, 0
    v_mov_b32 v222, 0
    v_mov_b32 v223, 0
    v_mov_b32 v224, 0
    v_mov_b32 v225, 0
    v_mov_b32 v226, 0
    v_mov_b32 v227, 0
    v_mov_b32 v228, 0
    v_mov_b32 v229, 0
    v_mov_b32 v230, 0
    v_mov_b32 v231, 0
    v_mov_b32 v232, 0
    v_mov_b32 v233, 0
    v_mov_b32 v234, 0
    v_mov_b32 v235, 0
    v_mov_b32 v236, 0
    v_mov_b32 v237, 0
    v_mov_b32 v238, 0
    v_mov_b32 v239, 0
    v_mov_b32 v240, 0
    v_mov_b32 v241, 0
    v_mov_b32 v242, 0
    v_mov_b32 v243, 0
    v_mov_b32 v244, 0
    v_mov_b32 v245, 0
    v_mov_b32 v246, 0
    v_mov_b32 v247, 0
    v_mov_b32 v248, 0
    v_mov_b32 v249, 0
    v_mov_b32 v250, 0
    v_mov_b32 v251, 0
    v_mov_b32 v252, 0
    v_mov_b32 v253, 0
    v_mov_b32 v254, 0
    v_mov_b32 v255, 0
    s_add_u32 m0, s29, 0
    s_nop 0
    buffer_load_dwordx4 v6, s[4:7], s20 offen lds
    s_add_u32 m0, s29, 1024
    s_nop 0
    buffer_load_dwordx4 v7, s[4:7], s20 offen lds
    s_add_u32 m0, s29, 2048
    s_nop 0
    buffer_load_dwordx4 v8, s[4:7], s20 offen lds
    s_add_u32 m0, s29, 3072
    s_nop 0
    buffer_load_dwordx4 v9, s[4:7], s20 offen lds
    s_add_u32 m0, s30, 0
    s_mov_b64 exec, s[32:33]
    buffer_load_dwordx4 v10, s[8:11], s21 offen lds
    s_mov_b64 exec, -1
    s_add_u32 m0, s30, 1024
    s_mov_b64 exec, s[34:35]
    buffer_load_dwordx4 v11, s[8:11], s21 offen lds
    s_mov_b64 exec, -1
    s_add_u32 m0, s30, 2048
    s_mov_b64 exec, s[36:37]
    buffer_load_dwordx4 v12, s[8:11], s21 offen lds
    s_mov_b64 exec, -1
    s_add_u32 m0, s30, 3072
    s_mov_b64 exec, s[38:39]
    buffer_load_dwordx4 v13, s[8:11], s21 offen lds
    s_mov_b64 exec, -1
    s_add_u32 m0, s30, 4096
    s_mov_b64 exec, s[40:41]
    buffer_load_dwordx4 v14, s[8:11], s21 offen lds
    s_mov_b64 exec, -1
    s_cmp_eq_u32 s42, 0
    s_cbranch_scc1 g1_no2_1
    s_add_u32 m0, s30, 0
    s_not_b64 exec, s[32:33]
    buffer_load_dwordx4 v10, s[12:15], s22 offen lds
    s_add_u32 m0, s30, 1024
    s_not_b64 exec, s[34:35]
    buffer_load_dwordx4 v11, s[12:15], s22 offen lds
    s_add_u32 m0, s30, 2048
    s_not_b64 exec, s[36:37]
    buffer_load_dwordx4 v12, s[12:15], s22 offen lds
    s_add_u32 m0, s30, 3072
    s_not_b64 exec, s[38:39]
    buffer_load_dwordx4 v13, s[12:15], s22 offen lds
    s_add_u32 m0, s30, 4096
    s_not_b64 exec, s[40:41]
    buffer_load_dwordx4 v14, s[12:15], s22 offen lds
    s_mov_b64 exec, -1
g1_no2_1:
    s_add_u32 s20, s20, 128
    s_add_u32 s21, s21, s23
    s_add_u32 s22, s22, s24
    s_add_u32 m0, s29, 32768
    s_nop 0
    buffer_load_dwordx4 v6, s[4:7], s20 offen lds
    s_add_u32 m0, s29, 33792
    s_nop 0
    buffer_load_dwordx4 v7, s[4:7], s20 offen lds
    s_add_u32 m0, s29, 34816
    s_nop 0
    buffer_load_dwordx4 v8, s[4:7], s20 offen lds
    s_add_u32 m0, s29, 35840
    s_nop 0
    buffer_load_dwordx4 v9, s[4:7], s20 offen lds
    s_add_u32 m0, s30, 40960
    s_mov_b64 exec, s[32:33]
    buffer_load_dwordx4 v10, s[8:11], s21 offen lds
    s_mov_b64 exec, -1
    s_add_u32 m0, s30, 41984
    s_mov_b64 exec, s[34:35]
    buffer_load_dwordx4 v11, s[8:11], s21 offen lds
    s_mov_b64 exec, -1
    s_add_u32 m0, s30, 43008
    s_mov_b64 exec, s[36:37]
    buffer_load_dwordx4 v12, s[8:11], s21 offen lds
    s_mov_b64 exec, -1
    s_add_u32 m0, s30, 44032
    s_mov_b64 exec, s[38:39]
    buffer_load_dwordx4 v13, s[8:11], s21 offen lds
    s_mov_b64 exec, -1
    s_add_u32 m0, s30, 45056
    s_mov_b64 exec, s[40:41]
    buffer_load_dwordx4 v14, s[8:11], s21 offen lds
    s_mov_b64 exec, -1
    s_cmp_eq_u32 s42, 0
    s_cbranch_scc1 g1_no2_2
    s_add_u32 m0, s30, 40960
    s_not_b64 exec, s[32:33]
    buffer_load_dwordx4 v10, s[12:15], s22 offen lds
    s_add_u32 m0, s30, 41984
    s_not_b64 exec, s[34:35]
    buffer_load_dwordx4 v11, s[12:15], s22 offen lds
    s_add_u32 m0, s30, 43008
    s_not_b64 exec, s[36:37]
    buffer_load_dwordx4 v12, s[12:15], s22 offen lds
    s_add_u32 m0, s30, 44032
    s_not_b64 exec, s[38:39]
    buffer_load_dwordx4 v13, s[12:15], s22 offen lds
    s_add_u32 m0, s30, 45056
    s_not_b64 exec, s[40:41]
    buffer_load_dwordx4 v14, s[12:15], s22 offen lds
    s_mov_b64 exec, -1
g1_no2_2:
    s_add_u32 s20, s20, 128
    s_add_u32 s21, s21, s23
    s_add_u32 s22, s22, s24
    s_waitcnt vmcnt(0)
    s_barrier
    ds_read_b128 v[40:43], v2 offset:0
    ds_read_b128 v[44:47], v2 offset:2048
    ds_read_b64_tr_b16 v[56:57], v4 offset:0
    ds_read_b64_tr_b16 v[58:59], v4 offset:2560
    ds_read_b64_tr_b16 v[60:61], v4 offset:32
    ds_read_b64_tr_b16 v[62:63], v4 offset:2592
    ds_read_b128 v[48:51], v2 offset:4096
    ds_read_b64_tr_b16 v[64:65], v4 offset:64
    ds_read_b64_tr_b16 v[66:67], v4 offset:2624
    ds_read_b64_tr_b16 v[68:69], v4 offset:96
    ds_read_b64_tr_b16 v[70:71], v4 offset:2656
    ds_read_b64_tr_b16 v[72:73], v4 offset:128
    ds_read_b128 v[52:55], v2 offset:6144
    ds_read_b64_tr_b16 v[74:75], v4 offset:2688
    ds_read_b64_tr_b16 v[76:77], v4 offset:20480
    ds_read_b64_tr_b16 v[78:79], v4 offset:23040
    ds_read_b64_tr_b16 v[80:81], v4 offset:20512
    ds_read_b64_tr_b16 v[82:83], v4 offset:23072
    ds_read_b64_tr_b16 v[84:85], v4 offset:20544
    ds_read_b64_tr_b16 v[86:87], v4 offset:23104
    ds_read_b64_tr_b16 v[88:89], v4 offset:20576
    ds_read_b64_tr_b16 v[90:91], v4 offset:23136
    ds_read_b64_tr_b16 v[92:93], v4 offset:20608
    ds_read_b64_tr_b16 v[94:95], v4 offset:23168
    s_mov_b32 s25, 0
g1_loop:
    s_waitcnt lgkmcnt(10)
    v_mfma_f32_16x16x32_bf16 v[96:99], v[56:59], v[40:43], v[96:99]
    v_mfma_f32_16x16x32_bf16 v[100:103], v[60:63], v[40:43], v[100:103]
    v_mfma_f32_16x16x32_bf16 v[104:107], v[64:67], v[40:43], v[104:107]
    v_mfma_f32_16x16x32_bf16 v[108:111], v[68:71], v[40:43], v[108:111]
    v_mfma_f32_16x16x32_bf16 v[112:115], v[72:75], v[40:43], v[112:115]
    v_mfma_f32_16x16x32_bf16 v[136:139], v[56:59], v[44:47], v[136:139]
    v_mfma_f32_16x16x32_bf16 v[140:143], v[60:63], v[44:47], v[140:143]
    v_mfma_f32_16x16x32_bf16 v[144:147], v[64:67], v[44:47], v[144:147]
    v_mfma_f32_16x16x32_bf16 v[148:151], v[68:71], v[44:47], v[148:151]
    v_mfma_f32_16x16x32_bf16 v[152:155], v[72:75], v[44:47], v[152:155]
    v_mfma_f32_16x16x32_bf16 v[176:179], v[56:59], v[48:51], v[176:179]
    v_mfma_f32_16x16x32_bf16 v[180:183], v[60:63], v[48:51], v[180:183]
    v_mfma_f32_16x16x32_bf16 v[184:187], v[64:67], v[48:51], v[184:187]
    v_mfma_f32_16x16x32_bf16 v[188:191], v[68:71], v[48:51], v[188:191]
    v_mfma_f32_16x16x32_bf16 v[192:195], v[72:75], v[48:51], v[192:195]
    v_mfma_f32_16x16x32_bf16 v[216:219], v[56:59], v[52:55], v[216:219]
    v_mfma_f32_16x16x32_bf16 v[220:223], v[60:63], v[52:55], v[220:223]
    v_mfma_f32_16x16x32_bf16 v[224:227], v[64:67], v[52:55], v[224:227]
    v_mfma_f32_16x16x32_bf16 v[228:231], v[68:71], v[52:55], v[228:231]
    v_mfma_f32_16x16x32_bf16 v[232:235], v[72:75], v[52:55], v[232:235]
    s_waitcnt lgkmcnt(0)
    v_mfma_f32_16x16x32_bf16 v[116:119], v[76:79], v[40:43], v[116:119]
    ds_read_b64_tr_b16 v[56:57], v4 offset:5120
    v_mfma_f32_16x16x32_bf16 v[120:123], v[80:83], v[40:43], v[120:123]
    ds_read_b64_tr_b16 v[58:59], v4 offset:7680
    v_mfma_f32_16x16x32_bf16 v[124:127], v[84:87], v[40:43], v[124:127]
    ds_read_b64_tr_b16 v[60:61], v4 offset:5152
    v_mfma_f32_16x16x32_bf16 v[128:131], v[88:91], v[40:43], v[128:131]
    ds_read_b64_tr_b16 v[62:63], v4 offset:7712
    v_mfma_f32_16x16x32_bf16 v[132:135], v[92:95], v[40:43], v[132:135]
    ds_read_b64_tr_b16 v[64:65], v4 offset:5184
    ds_read_b128 v[40:43], v3 offset:0
    v_mfma_f32_16x16x32_bf16 v[156:159], v[76:79], v[44:47], v[156:159]
    ds_read_b64_tr_b16 v[66:67], v4 offset:7744
    v_mfma_f32_16x16x32_bf16 v[160:163], v[80:83], v[44:47], v[160:163]
    ds_read_b64_tr_b16 v[68:69], v4 offset:5216
    v_mfma_f32_16x16x32_bf16 v[164:167], v[84:87], v[44:47], v[164:167]
    ds_read_b64_tr_b16 v[70:71], v4 offset:7776
    v_mfma_f32_16x16x32_bf16 v[168:171], v[88:91], v[44:47], v[168:171]
    ds_read_b64_tr_b16 v[72:73], v4 offset:5248
    v_mfma_f32_16x16x32_bf16 v[172:175], v[92:95], v[44:47], v[172:175]
    ds_read_b64_tr_b16 v[74:75], v4 offset:7808
    ds_read_b128 v[44:47], v3 offset:2048
    v_mfma_f32_16x16x32_bf16 v[196:199], v[76:79], v[48:51], v[196:199]
    v_mfma_f32_16x16x32_bf16 v[200:203], v[80:83], v[48:51], v[200:203]
    v_mfma_f32_16x16x32_bf16 v[204:207], v[84:87], v[48:51], v[204:207]
    v_mfma_f32_16x16x32_bf16 v[208:211], v[88:91], v[48:51], v[208:211]
    v_mfma_f32_16x16x32_bf16 v[212:215], v[92:95], v[48:51], v[212:215]
    ds_read_b128 v[48:51], v3 offset:4096
    v_mfma_f32_16x16x32_bf16 v[236:239], v[76:79], v[52:55], v[236:239]
    v_mfma_f32_16x16x32_bf16 v[240:243], v[80:83], v[52:55], v[240:243]
    v_mfma_f32_16x16x32_bf16 v[244:247], v[84:87], v[52:55], v[244:247]
    v_mfma_f32_16x16x32_bf16 v[248:251], v[88:91], v[52:55], v[248:251]
    v_mfma_f32_16x16x32_bf16 v[252:255], v[92:95], v[52:55], v[252:255]
    ds_read_b128 v[52:55], v3 offset:6144
    s_waitcnt lgkmcnt(3)
    v_mfma_f32_16x16x32_bf16 v[96:99], v[56:59], v[40:43], v[96:99]
    ds_read_b64_tr_b16 v[76:77], v4 offset:25600
    v_mfma_f32_16x16x32_bf16 v[100:103], v[60:63], v[40:43], v[100:103]
    ds_read_b64_tr_b16 v[78:79], v4 offset:28160
    v_mfma_f32_16x16x32_bf16 v[104:107], v[64:67], v[40:43], v[104:107]
    ds_read_b64_tr_b16 v[80:81], v4 offset:25632
    v_mfma_f32_16x16x32_bf16 v[108:111], v[68:71], v[40:43], v[108:111]
    ds_read_b64_tr_b16 v[82:83], v4 offset:28192
    v_mfma_f32_16x16x32_bf16 v[112:115], v[72:75], v[40:43], v[112:115]
    ds_read_b64_tr_b16 v[84:85], v4 offset:25664
    s_waitcnt lgkmcnt(7)
    v_mfma_f32_16x16x32_bf16 v[136:139], v[56:59], v[44:47], v[136:139]
    ds_read_b64_tr_b16 v[86:87], v4 offset:28224
    v_mfma_f32_16x16x32_bf16 v[140:143], v[60:63], v[44:47], v[140:143]
    ds_read_b64_tr_b16 v[88:89], v4 offset:25696
    v_mfma_f32_16x16x32_bf16 v[144:147], v[64:67], v[44:47], v[144:147]
    ds_read_b64_tr_b16 v[90:91], v4 offset:28256
    v_mfma_f32_16x16x32_bf16 v[148:151], v[68:71], v[44:47], v[148:151]
    ds_read_b64_tr_b16 v[92:93], v4 offset:25728
    v_mfma_f32_16x16x32_bf16 v[152:155], v[72:75], v[44:47], v[152:155]
    ds_read_b64_tr_b16 v[94:95], v4 offset:28288
    s_waitcnt lgkmcnt(11)
    v_mfma_f32_16x16x32_bf16 v[176:179], v[56:59], v[48:51], v[176:179]
    v_mfma_f32_16x16x32_bf16 v[180:183], v[60:63], v[48:51], v[180:183]
    v_mfma_f32_16x16x32_bf16 v[184:187], v[64:67], v[48:51], v[184:187]
    v_mfma_f32_16x16x32_bf16 v[188:191], v[68:71], v[48:51], v[188:191]
    v_mfma_f32_16x16x32_bf16 v[192:195], v[72:75], v[48:51], v[192:195]
    s_waitcnt lgkmcnt(10)
    v_mfma_f32_16x16x32_bf16 v[216:219], v[56:59], v[52:55], v[216:219]
    v_mfma_f32_16x16x32_bf16 v[220:223], v[60:63], v[52:55], v[220:223]
    v_mfma_f32_16x16x32_bf16 v[224:227], v[64:67], v[52:55], v[224:227]
    v_mfma_f32_16x16x32_bf16 v[228:231], v[68:71], v[52:55], v[228:231]
    v_mfma_f32_16x16x32_bf16 v[232:235], v[72:75], v[52:55], v[232:235]
    s_waitcnt lgkmcnt(0)
    s_waitcnt lgkmcnt(0)
    s_waitcnt vmcnt(0)
    s_barrier
    v_mfma_f32_16x16x32_bf16 v[116:119], v[76:79], v[40:43], v[116:119]
    s_add_u32 m0, s29, 0
    s_nop 0
    buffer_load_dwordx4 v6, s[4:7], s20 offen lds
    v_mfma_f32_16x16x32_bf16 v[120:123], v[80:83], v[40:43], v[120:123]
    s_add_u32 m0, s29, 1024
    s_nop 0
    buffer_load_dwordx4 v7, s[4:7], s20 offen lds
    v_mfma_f32_16x16x32_bf16 v[124:127], v[84:87], v[40:43], v[124:127]
    s_add_u32 m0, s29, 2048
    s_nop 0
    buffer_load_dwordx4 v8, s[4:7], s20 offen lds
    v_mfma_f32_16x16x32_bf16 v[128:131], v[88:91], v[40:43], v[128:131]
    s_add_u32 m0, s29, 3072
    s_nop 0
    buffer_load_dwordx4 v9, s[4:7], s20 offen lds
    v_mfma_f32_16x16x32_bf16 v[132:135], v[92:95], v[40:43], v[132:135]
    s_add_u32 m0, s30, 0
    s_mov_b64 exec, s[32:33]
    buffer_load_dwordx4 v10, s[8:11], s21 offen lds
    s_mov_b64 exec, -1
    ds_read_b128 v[40:43], v2 offset:32768
    v_mfma_f32_16x16x32_bf16 v[156:159], v[76:79], v[44:47], v[156:159]
    s_add_u32 m0, s30, 1024
    s_mov_b64 exec, s[34:35]
    buffer_load_dwordx4 v11, s[8:11], s21 offen lds
    s_mov_b64 exec, -1
    v_mfma_f32_16x16x32_bf16 v[160:163], v[80:83], v[44:47], v[160:163]
    s_add_u32 m0, s30, 2048
    s_mov_b64 exec, s[36:37]
    buffer_load_dwordx4 v12, s[8:11], s21 offen lds
    s_mov_b64 exec, -1
    v_mfma_f32_16x16x32_bf16 v[164:167], v[84:87], v[44:47], v[164:167]
    s_add_u32 m0, s30, 3072
    s_mov_b64 exec, s[38:39]
    buffer_load_dwordx4 v13, s[8:11], s21 offen lds
    s_mov_b64 exec, -1
    v_mfma_f32_16x16x32_bf16 v[168:171], v[88:91], v[44:47], v[168:171]
    s_add_u32 m0, s30, 4096
    s_mov_b64 exec, s[40:41]
    buffer_load_dwordx4 v14, s[8:11], s21 offen lds
    s_mov_b64 exec, -1
    v_mfma_f32_16x16x32_bf16 v[172:175], v[92:95], v[44:47], v[172:175]
    s_cmp_eq_u32 s42, 0
    s_cbranch_scc1 g1_no2_3
    s_add_u32 m0, s30, 0
    s_not_b64 exec, s[32:33]
    buffer_load_dwordx4 v10, s[12:15], s22 offen lds
    s_add_u32 m0, s30, 1024
    s_not_b64 exec, s[34:35]
    buffer_load_dwordx4 v11, s[12:15], s22 offen lds
    s_add_u32 m0, s30, 2048
    s_not_b64 exec, s[36:37]
    buffer_load_dwordx4 v12, s[12:15], s22 offen lds
    s_add_u32 m0, s30, 3072
    s_not_b64 exec, s[38:39]
    buffer_load_dwordx4 v13, s[12:15], s22 offen lds
    s_add_u32 m0, s30, 4096
    s_not_b64 exec, s[40:41]
    buffer_load_dwordx4 v14, s[12:15], s22 offen lds
    s_mov_b64 exec, -1
g1_no2_3:
    ds_read_b128 v[44:47], v2 offset:34816
    v_mfma_f32_16x16x32_bf16 v[196:199], v[76:79], v[48:51], v[196:199]
    s_add_u32 s20, s20, 128
    s_add_u32 s21, s21, s23
    s_add_u32 s22, s22, s24
    v_mfma_f32_16x16x32_bf16 v[200:203], v[80:83], v[48:51], v[200:203]
    ds_read_b64_tr_b16 v[56:57], v5 offset:0
    v_mfma_f32_16x16x32_bf16 v[204:207], v[84:87], v[48:51], v[204:207]
    ds_read_b64_tr_b16 v[58:59], v5 offset:2560
    v_mfma_f32_16x16x32_bf16 v[208:211], v[88:91], v[48:51], v[208:211]
    ds_read_b64_tr_b16 v[60:61], v5 offset:32
    v_mfma_f32_16x16x32_bf16 v[212:215], v[92:95], v[48:51], v[212:215]
    ds_read_b64_tr_b16 v[62:63], v5 offset:2592
    ds_read_b128 v[48:51], v2 offset:36864
    v_mfma_f32_16x16x32_bf16 v[236:239], v[76:79], v[52:55], v[236:239]
    ds_read_b64_tr_b16 v[64:65], v5 offset:64
    v_mfma_f32_16x16x32_bf16 v[240:243], v[80:83], v[52:55], v[240:243]
    ds_read_b64_tr_b16 v[66:67], v5 offset:2624
    v_mfma_f32_16x16x32_bf16 v[244:247], v[84:87], v[52:55], v[244:247]
    ds_read_b64_tr_b16 v[68:69], v5 offset:96
    v_mfma_f32_16x16x32_bf16 v[248:251], v[88:91], v[52:55], v[248:251]
    ds_read_b64_tr_b16 v[70:71], v5 offset:2656
    v_mfma_f32_16x16x32_bf16 v[252:255], v[92:95], v[52:55], v[252:255]
    ds_read_b64_tr_b16 v[72:73], v5 offset:128
    ds_read_b128 v[52:55], v2 offset:38912
    ds_read_b64_tr_b16 v[74:75], v5 offset:2688
    ds_read_b64_tr_b16 v[76:77], v5 offset:20480
    ds_read_b64_tr_b16 v[78:79], v5 offset:23040
    ds_read_b64_tr_b16 v[80:81], v5 offset:20512
    ds_read_b64_tr_b16 v[82:83], v5 offset:23072
    ds_read_b64_tr_b16 v[84:85], v5 offset:20544
    ds_read_b64_tr_b16 v[86:87], v5 offset:23104
    ds_read_b64_tr_b16 v[88:89], v5 offset:20576
    ds_read_b64_tr_b16 v[90:91], v5 offset:23136
    ds_read_b64_tr_b16 v[92:93], v5 offset:20608
    ds_read_b64_tr_b16 v[94:95], v5 offset:23168
    s_waitcnt lgkmcnt(10)
    v_mfma_f32_16x16x32_bf16 v[96:99], v[56:59], v[40:43], v[96:99]
    v_mfma_f32_16x16x32_bf16 v[100:103], v[60:63], v[40:43], v[100:103]
    v_mfma_f32_16x16x32_bf16 v[104:107], v[64:67], v[40:43], v[104:107]
    v_mfma_f32_16x16x32_bf16 v[108:111], v[68:71], v[40:43], v[108:111]
    v_mfma_f32_16x16x32_bf16 v[112:115], v[72:75], v[40:43], v[112:115]
    v_mfma_f32_16x16x32_bf16 v[136:139], v[56:59], v[44:47], v[136:139]
    v_mfma_f32_16x16x32_bf16 v[140:143], v[60:63], v[44:47], v[140:143]
    v_mfma_f32_16x16x32_bf16 v[144:147], v[64:67], v[44:47], v[144:147]
    v_mfma_f32_16x16x32_bf16 v[148:151], v[68:71], v[44:47], v[148:151]
    v_mfma_f32_16x16x32_bf16 v[152:155], v[72:75], v[44:47], v[152:155]
    v_mfma_f32_16x16x32_bf16 v[176:179], v[56:59], v[48:51], v[176:179]
    v_mfma_f32_16x16x32_bf16 v[180:183], v[60:63], v[48:51], v[180:183]
    v_mfma_f32_16x16x32_bf16 v[184:187], v[64:67], v[48:51], v[184:187]
    v_mfma_f32_16x16x32_bf16 v[188:191], v[68:71], v[48:51], v[188:191]
    v_mfma_f32_16x16x32_bf16 v[192:195], v[72:75], v[48:51], v[192:195]
    v_mfma_f32_16x16x32_bf16 v[216:219], v[56:59], v[52:55], v[216:219]
    v_mfma_f32_16x16x32_bf16 v[220:223], v[60:63], v[52:55], v[220:223]
    v_mfma_f32_16x16x32_bf16 v[224:227], v[64:67], v[52:55], v[224:227]
    v_mfma_f32_16x16x32_bf16 v[228:231], v[68:71], v[52:55], v[228:231]
    v_mfma_f32_16x16x32_bf16 v[232:235], v[72:75], v[52:55], v[232:235]
    s_waitcnt lgkmcnt(0)
    v_mfma_f32_16x16x32_bf16 v[116:119], v[76:79], v[40:43], v[116:119]
    ds_read_b64_tr_b16 v[56:57], v5 offset:5120
    v_mfma_f32_16x16x32_bf16 v[120:123], v[80:83], v[40:43], v[120:123]
    ds_read_b64_tr_b16 v[58:59], v5 offset:7680
    v_mfma_f32_16x16x32_bf16 v[124:127], v[84:87], v[40:43], v[124:127]
    ds_read_b64_tr_b16 v[60:61], v5 offset:5152
    v_mfma_f32_16x16x32_bf16 v[128:131], v[88:91], v[40:43], v[128:131]
    ds_read_b64_tr_b16 v[62:63], v5 offset:7712
    v_mfma_f32_16x16x32_bf16 v[132:135], v[92:95], v[40:43], v[132:135]
    ds_read_b64_tr_b16 v[64:65], v5 offset:5184
    ds_read_b128 v[40:43], v3 offset:32768
    v_mfma_f32_16x16x32_bf16 v[156:159], v[76:79], v[44:47], v[156:159]
    ds_read_b64_tr_b16 v[66:67], v5 offset:7744
    v_mfma_f32_16x16x32_bf16 v[160:163], v[80:83], v[44:47], v[160:163]
    ds_read_b64_tr_b16 v[68:69], v5 offset:5216
    v_mfma_f32_16x16x32_bf16 v[164:167], v[84:87], v[44:47], v[164:167]
    ds_read_b64_tr_b16 v[70:71], v5 offset:7776
    v_mfma_f32_16x16x32_bf16 v[168:171], v[88:91], v[44:47], v[168:171]
    ds_read_b64_tr_b16 v[72:73], v5 offset:5248
    v_mfma_f32_16x16x32_bf16 v[172:175], v[92:95], v[44:47], v[172:175]
    ds_read_b64_tr_b16 v[74:75], v5 offset:7808
    ds_read_b128 v[44:47], v3 offset:34816
    v_mfma_f32_16x16x32_bf16 v[196:199], v[76:79], v[48:51], v[196:199]
    v_mfma_f32_16x16x32_bf16 v[200:203], v[80:83], v[48:51], v[200:203]
    v_mfma_f32_16x16x32_bf16 v[204:207], v[84:87], v[48:51], v[204:207]
    v_mfma_f32_16x16x32_bf16 v[208:211], v[88:91], v[48:51], v[208:211]
    v_mfma_f32_16x16x32_bf16 v[212:215], v[92:95], v[48:51], v[212:215]
    ds_read_b128 v[48:51], v3 offset:36864
    v_mfma_f32_16x16x32_bf16 v[236:239], v[76:79], v[52:55], v[236:239]
    v_mfma_f32_16x16x32_bf16 v[240:243], v[80:83], v[52:55], v[240:243]
    v_mfma_f32_16x16x32_bf16 v[244:247], v[84:87], v[52:55], v[244:247]
    v_mfma_f32_16x16x32_bf16 v[248:251], v[88:91], v[52:55], v[248:251]
    v_mfma_f32_16x16x32_bf16 v[252:255], v[92:95], v[52:55], v[252:255]
    ds_read_b128 v[52:55], v3 offset:38912
    s_waitcnt lgkmcnt(3)
    v_mfma_f32_16x16x32_bf16 v[96:99], v[56:59], v[40:43], v[96:99]
    ds_read_b64_tr_b16 v[76:77], v5 offset:25600
    v_mfma_f32_16x16x32_bf16 v[100:103], v[60:63], v[40:43], v[100:103]
    ds_read_b64_tr_b16 v[78:79], v5 offset:28160
    v_mfma_f32_16x16x32_bf16 v[104:107], v[64:67], v[40:43], v[104:107]
    ds_read_b64_tr_b16 v[80:81], v5 offset:25632
    v_mfma_f32_16x16x32_bf16 v[108:111], v[68:71], v[40:43], v[108:111]
    ds_read_b64_tr_b16 v[82:83], v5 offset:28192
    v_mfma_f32_16x16x32_bf16 v[112:115], v[72:75], v[40:43], v[112:115]
    ds_read_b64_tr_b16 v[84:85], v5 offset:25664
    s_waitcnt lgkmcnt(7)
    v_mfma_f32_16x16x32_bf16 v[136:139], v[56:59], v[44:47], v[136:139]
    ds_read_b64_tr_b16 v[86:87], v5 offset:28224
    v_mfma_f32_16x16x32_bf16 v[140:143], v[60:63], v[44:47], v[140:143]
    ds_read_b64_tr_b16 v[88:89], v5 offset:25696
    v_mfma_f32_16x16x32_bf16 v[144:147], v[64:67], v[44:47], v[144:147]
    ds_read_b64_tr_b16 v[90:91], v5 offset:28256
    v_mfma_f32_16x16x32_bf16 v[148:151], v[68:71], v[44:47], v[148:151]
    ds_read_b64_tr_b16 v[92:93], v5 offset:25728
    v_mfma_f32_16x16x32_bf16 v[152:155], v[72:75], v[44:47], v[152:155]
    ds_read_b64_tr_b16 v[94:95], v5 offset:28288
    s_waitcnt lgkmcnt(11)
    v_mfma_f32_16x16x32_bf16 v[176:179], v[56:59], v[48:51], v[176:179]
    v_mfma_f32_16x16x32_bf16 v[180:183], v[60:63], v[48:51], v[180:183]
    v_mfma_f32_16x16x32_bf16 v[184:187], v[64:67], v[48:51], v[184:187]
    v_mfma_f32_16x16x32_bf16 v[188:191], v[68:71], v[48:51], v[188:191]
    v_mfma_f32_16x16x32_bf16 v[192:195], v[72:75], v[48:51], v[192:195]
    s_waitcnt lgkmcnt(10)
    v_mfma_f32_16x16x32_bf16 v[216:219], v[56:59], v[52:55], v[216:219]
    v_mfma_f32_16x16x32_bf16 v[220:223], v[60:63], v[52:55], v[220:223]
    v_mfma_f32_16x16x32_bf16 v[224:227], v[64:67], v[52:55], v[224:227]
    v_mfma_f32_16x16x32_bf16 v[228:231], v[68:71], v[52:55], v[228:231]
    v_mfma_f32_16x16x32_bf16 v[232:235], v[72:75], v[52:55], v[232:235]
    s_waitcnt lgkmcnt(0)
    s_waitcnt lgkmcnt(0)
    s_waitcnt vmcnt(0)
    s_barrier
    v_mfma_f32_16x16x32_bf16 v[116:119], v[76:79], v[40:43], v[116:119]
    s_add_u32 m0, s29, 32768
    s_nop 0
    buffer_load_dwordx4 v6, s[4:7], s20 offen lds
    v_mfma_f32_16x16x32_bf16 v[120:123], v[80:83], v[40:43], v[120:123]
    s_add_u32 m0, s29, 33792
    s_nop 0
    buffer_load_dwordx4 v7, s[4:7], s20 offen lds
    v_mfma_f32_16x16x32_bf16 v[124:127], v[84:87], v[40:43], v[124:127]
    s_add_u32 m0, s29, 34816
    s_nop 0
    buffer_load_dwordx4 v8, s[4:7], s20 offen lds
    v_mfma_f32_16x16x32_bf16 v[128:131], v[88:91], v[40:43], v[128:131]
    s_add_u32 m0, s29, 35840
    s_nop 0
    buffer_load_dwordx4 v9, s[4:7], s20 offen lds
    v_mfma_f32_16x16x32_bf16 v[132:135], v[92:95], v[40:43], v[132:135]
    s_add_u32 m0, s30, 40960
    s_mov_b64 exec, s[32:33]
    buffer_load_dwordx4 v10, s[8:11], s21 offen lds
    s_mov_b64 exec, -1
    ds_read_b128 v[40:43], v2 offset:0
    v_mfma_f32_16x16x32_bf16 v[156:159], v[76:79], v[44:47], v[156:159]
    s_add_u32 m0, s30, 41984
    s_mov_b64 exec, s[34:35]
    buffer_load_dwordx4 v11, s[8:11], s21 offen lds
    s_mov_b64 exec, -1
    v_mfma_f32_16x16x32_bf16 v[160:163], v[80:83], v[44:47], v[160:163]
    s_add_u32 m0, s30, 43008
    s_mov_b64 exec, s[36:37]
    buffer_load_dwordx4 v12, s[8:11], s21 offen lds
    s_mov_b64 exec, -1
    v_mfma_f32_16x16x32_bf16 v[164:167], v[84:87], v[44:47], v[164:167]
    s_add_u32 m0, s30, 44032
    s_mov_b64 exec, s[38:39]
    buffer_load_dwordx4 v13, s[8:11], s21 offen lds
    s_mov_b64 exec, -1
    v_mfma_f32_16x16x32_bf16 v[168:171], v[88:91], v[44:47], v[168:171]
    s_add_u32 m0, s30, 45056
    s_mov_b64 exec, s[40:41]
    buffer_load_dwordx4 v14, s[8:11], s21 offen lds
    s_mov_b64 exec, -1
    v_mfma_f32_16x16x32_bf16 v[172:175], v[92:95], v[44:47], v[172:175]
    s_cmp_eq_u32 s42, 0
    s_cbranch_scc1 g1_no2_4
    s_add_u32 m0, s30, 40960
    s_not_b64 exec, s[32:33]
    buffer_load_dwordx4 v10, s[12:15], s22 offen lds
    s_add_u32 m0, s30, 41984
    s_not_b64 exec, s[34:35]
    buffer_load_dwordx4 v11, s[12:15], s22 offen lds
    s_add_u32 m0, s30, 43008
    s_not_b64 exec, s[36:37]
    buffer_load_dwordx4 v12, s[12:15], s22 offen lds
    s_add_u32 m0, s30, 44032
    s_not_b64 exec, s[38:39]
    buffer_load_dwordx4 v13, s[12:15], s22 offen lds
    s_add_u32 m0, s30, 45056
    s_not_b64 exec, s[40:41]
    buffer_load_dwordx4 v14, s[12:15], s22 offen lds
    s_mov_b64 exec, -1
g1_no2_4:
    ds_read_b128 v[44:47], v2 offset:2048
    v_mfma_f32_16x16x32_bf16 v[196:199], v[76:79], v[48:51], v[196:199]
    s_add_u32 s20, s20, 128
    s_add_u32 s21, s21, s23
    s_add_u32 s22, s22, s24
    v_mfma_f32_16x16x32_bf16 v[200:203], v[80:83], v[48:51], v[200:203]
    ds_read_b64_tr_b16 v[56:57], v4 offset:0
    v_mfma_f32_16x16x32_bf16 v[204:207], v[84:87], v[48:51], v[204:207]
    ds_read_b64_tr_b16 v[58:59], v4 offset:2560
    v_mfma_f32_16x16x32_bf16 v[208:211], v[88:91], v[48:51], v[208:211]
    ds_read_b64_tr_b16 v[60:61], v4 offset:32
    v_mfma_f32_16x16x32_bf16 v[212:215], v[92:95], v[48:51], v[212:215]
    ds_read_b64_tr_b16 v[62:63], v4 offset:2592
    ds_read_b128 v[48:51], v2 offset:4096
    v_mfma_f32_16x16x32_bf16 v[236:239], v[76:79], v[52:55], v[236:239]
    ds_read_b64_tr_b16 v[64:65], v4 offset:64
    v_mfma_f32_16x16x32_bf16 v[240:243], v[80:83], v[52:55], v[240:243]
    ds_read_b64_tr_b16 v[66:67], v4 offset:2624
    v_mfma_f32_16x16x32_bf16 v[244:247], v[84:87], v[52:55], v[244:247]
    ds_read_b64_tr_b16 v[68:69], v4 offset:96
    v_mfma_f32_16x16x32_bf16 v[248:251], v[88:91], v[52:55], v[248:251]
    ds_read_b64_tr_b16 v[70:71], v4 offset:2656
    v_mfma_f32_16x16x32_bf16 v[252:255], v[92:95], v[52:55], v[252:255]
    ds_read_b64_tr_b16 v[72:73], v4 offset:128
    ds_read_b128 v[52:55], v2 offset:6144
    ds_read_b64_tr_b16 v[74:75], v4 offset:2688
    ds_read_b64_tr_b16 v[76:77], v4 offset:20480
    ds_read_b64_tr_b16 v[78:79], v4 offset:23040
    ds_read_b64_tr_b16 v[80:81], v4 offset:20512
    ds_read_b64_tr_b16 v[82:83], v4 offset:23072
    ds_read_b64_tr_b16 v[84:85], v4 offset:20544
    ds_read_b64_tr_b16 v[86:87], v4 offset:23104
    ds_read_b64_tr_b16 v[88:89], v4 offset:20576
    ds_read_b64_tr_b16 v[90:91], v4 offset:23136
    ds_read_b64_tr_b16 v[92:93], v4 offset:20608
    ds_read_b64_tr_b16 v[94:95], v4 offset:23168
    s_add_u32 s25, s25, 1
    s_cmp_lt_u32 s25, 7
    s_cbranch_scc1 g1_loop
    s_waitcnt lgkmcnt(10)
    v_mfma_f32_16x16x32_bf16 v[96:99], v[56:59], v[40:43], v[96:99]
    v_mfma_f32_16x16x32_bf16 v[100:103], v[60:63], v[40:43], v[100:103]
    v_mfma_f32_16x16x32_bf16 v[104:107], v[64:67], v[40:43], v[104:107]
    v_mfma_f32_16x16x32_bf16 v[108:111], v[68:71], v[40:43], v[108:111]
    v_mfma_f32_16x16x32_bf16 v[112:115], v[72:75], v[40:43], v[112:115]
    v_mfma_f32_16x16x32_bf16 v[136:139], v[56:59], v[44:47], v[136:139]
    v_mfma_f32_16x16x32_bf16 v[140:143], v[60:63], v[44:47], v[140:143]
    v_mfma_f32_16x16x32_bf16 v[144:147], v[64:67], v[44:47], v[144:147]
    v_mfma_f32_16x16x32_bf16 v[148:151], v[68:71], v[44:47], v[148:151]
    v_mfma_f32_16x16x32_bf16 v[152:155], v[72:75], v[44:47], v[152:155]
    v_mfma_f32_16x16x32_bf16 v[176:179], v[56:59], v[48:51], v[176:179]
    v_mfma_f32_16x16x32_bf16 v[180:183], v[60:63], v[48:51], v[180:183]
    v_mfma_f32_16x16x32_bf16 v[184:187], v[64:67], v[48:51], v[184:187]
    v_mfma_f32_16x16x32_bf16 v[188:191], v[68:71], v[48:51], v[188:191]
    v_mfma_f32_16x16x32_bf16 v[192:195], v[72:75], v[48:51], v[192:195]
    v_mfma_f32_16x16x32_bf16 v[216:219], v[56:59], v[52:55], v[216:219]
    v_mfma_f32_16x16x32_bf16 v[220:223], v[60:63], v[52:55], v[220:223]
    v_mfma_f32_16x16x32_bf16 v[224:227], v[64:67], v[52:55], v[224:227]
    v_mfma_f32_16x16x32_bf16 v[228:231], v[68:71], v[52:55], v[228:231]
    v_mfma_f32_16x16x32_bf16 v[232:235], v[72:75], v[52:55], v[232:235]
    s_waitcnt lgkmcnt(0)
    v_mfma_f32_16x16x32_bf16 v[116:119], v[76:79], v[40:43], v[116:119]
    ds_read_b64_tr_b16 v[56:57], v4 offset:5120
    v_mfma_f32_16x16x32_bf16 v[120:123], v[80:83], v[40:43], v[120:123]
    ds_read_b64_tr_b16 v[58:59], v4 offset:7680
    v_mfma_f32_16x16x32_bf16 v[124:127], v[84:87], v[40:43], v[124:127]
    ds_read_b64_tr_b16 v[60:61], v4 offset:5152
    v_mfma_f32_16x16x32_bf16 v[128:131], v[88:91], v[40:43], v[128:131]
    ds_read_b64_tr_b16 v[62:63], v4 offset:7712
    v_mfma_f32_16x16x32_bf16 v[132:135], v[92:95], v[40:43], v[132:135]
    ds_read_b64_tr_b16 v[64:65], v4 offset:5184
    ds_read_b128 v[40:43], v3 offset:0
    v_mfma_f32_16x16x32_bf16 v[156:159], v[76:79], v[44:47], v[156:159]
    ds_read_b64_tr_b16 v[66:67], v4 offset:7744
    v_mfma_f32_16x16x32_bf16 v[160:163], v[80:83], v[44:47], v[160:163]
    ds_read_b64_tr_b16 v[68:69], v4 offset:5216
    v_mfma_f32_16x16x32_bf16 v[164:167], v[84:87], v[44:47], v[164:167]
    ds_read_b64_tr_b16 v[70:71], v4 offset:7776
    v_mfma_f32_16x16x32_bf16 v[168:171], v[88:91], v[44:47], v[168:171]
    ds_read_b64_tr_b16 v[72:73], v4 offset:5248
    v_mfma_f32_16x16x32_bf16 v[172:175], v[92:95], v[44:47], v[172:175]
    ds_read_b64_tr_b16 v[74:75], v4 offset:7808
    ds_read_b128 v[44:47], v3 offset:2048
    v_mfma_f32_16x16x32_bf16 v[196:199], v[76:79], v[48:51], v[196:199]
    v_mfma_f32_16x16x32_bf16 v[200:203], v[80:83], v[48:51], v[200:203]
    v_mfma_f32_16x16x32_bf16 v[204:207], v[84:87], v[48:51], v[204:207]
    v_mfma_f32_16x16x32_bf16 v[208:211], v[88:91], v[48:51], v[208:211]
    v_mfma_f32_16x16x32_bf16 v[212:215], v[92:95], v[48:51], v[212:215]
    ds_read_b128 v[48:51], v3 offset:4096
    v_mfma_f32_16x16x32_bf16 v[236:239], v[76:79], v[52:55], v[236:239]
    v_mfma_f32_16x16x32_bf16 v[240:243], v[80:83], v[52:55], v[240:243]
    v_mfma_f32_16x16x32_bf16 v[244:247], v[84:87], v[52:55], v[244:247]
    v_mfma_f32_16x16x32_bf16 v[248:251], v[88:91], v[52:55], v[248:251]
    v_mfma_f32_16x16x32_bf16 v[252:255], v[92:95], v[52:55], v[252:255]
    ds_read_b128 v[52:55], v3 offset:6144
    s_waitcnt lgkmcnt(3)
    v_mfma_f32_16x16x32_bf16 v[96:99], v[56:59], v[40:43], v[96:99]
    ds_read_b64_tr_b16 v[76:77], v4 offset:25600
    v_mfma_f32_16x16x32_bf16 v[100:103], v[60:63], v[40:43], v[100:103]
    ds_read_b64_tr_b16 v[78:79], v4 offset:28160
    v_mfma_f32_16x16x32_bf16 v[104:107], v[64:67], v[40:43], v[104:107]
    ds_read_b64_tr_b16 v[80:81], v4 offset:25632
    v_mfma_f32_16x16x32_bf16 v[108:111], v[68:71], v[40:43], v[108:111]
    ds_read_b64_tr_b16 v[82:83], v4 offset:28192
    v_mfma_f32_16x16x32_bf16 v[112:115], v[72:75], v[40:43], v[112:115]
    ds_read_b64_tr_b16 v[84:85], v4 offset:25664
    s_waitcnt lgkmcnt(7)
    v_mfma_f32_16x16x32_bf16 v[136:139], v[56:59], v[44:47], v[136:139]
    ds_read_b64_tr_b16 v[86:87], v4 offset:28224
    v_mfma_f32_16x16x32_bf16 v[140:143], v[60:63], v[44:47], v[140:143]
    ds_read_b64_tr_b16 v[88:89], v4 offset:25696
    v_mfma_f32_16x16x32_bf16 v[144:147], v[64:67], v[44:47], v[144:147]
    ds_read_b64_tr_b16 v[90:91], v4 offset:28256
    v_mfma_f32_16x16x32_bf16 v[148:151], v[68:71], v[44:47], v[148:151]
    ds_read_b64_tr_b16 v[92:93], v4 offset:25728
    v_mfma_f32_16x16x32_bf16 v[152:155], v[72:75], v[44:47], v[152:155]
    ds_read_b64_tr_b16 v[94:95], v4 offset:28288
    s_waitcnt lgkmcnt(11)
    v_mfma_f32_16x16x32_bf16 v[176:179], v[56:59], v[48:51], v[176:179]
    v_mfma_f32_16x16x32_bf16 v[180:183], v[60:63], v[48:51], v[180:183]
    v_mfma_f32_16x16x32_bf16 v[184:187], v[64:67], v[48:51], v[184:187]
    v_mfma_f32_16x16x32_bf16 v[188:191], v[68:71], v[48:51], v[188:191]
    v_mfma_f32_16x16x32_bf16 v[192:195], v[72:75], v[48:51], v[192:195]
    s_waitcnt lgkmcnt(10)
    v_mfma_f32_16x16x32_bf16 v[216:219], v[56:59], v[52:55], v[216:219]
    v_mfma_f32_16x16x32_bf16 v[220:223], v[60:63], v[52:55], v[220:223]
    v_mfma_f32_16x16x32_bf16 v[224:227], v[64:67], v[52:55], v[224:227]
    v_mfma_f32_16x16x32_bf16 v[228:231], v[68:71], v[52:55], v[228:231]
    v_mfma_f32_16x16x32_bf16 v[232:235], v[72:75], v[52:55], v[232:235]
    s_waitcnt lgkmcnt(0)
    s_waitcnt lgkmcnt(0)
    s_waitcnt vmcnt(0)
    s_barrier
    v_mfma_f32_16x16x32_bf16 v[116:119], v[76:79], v[40:43], v[116:119]
    ds_read_b64_tr_b16 v[56:57], v5 offset:0
    v_mfma_f32_16x16x32_bf16 v[120:123], v[80:83], v[40:43], v[120:123]
    ds_read_b64_tr_b16 v[58:59], v5 offset:2560
    v_mfma_f32_16x16x32_bf16 v[124:127], v[84:87], v[40:43], v[124:127]
    ds_read_b64_tr_b16 v[60:61], v5 offset:32
    v_mfma_f32_16x16x32_bf16 v[128:131], v[88:91], v[40:43], v[128:131]
    ds_read_b64_tr_b16 v[62:63], v5 offset:2592
    v_mfma_f32_16x16x32_bf16 v[132:135], v[92:95], v[40:43], v[132:135]
    ds_read_b64_tr_b16 v[64:65], v5 offset:64
    ds_read_b128 v[40:43], v2 offset:32768
    v_mfma_f32_16x16x32_bf16 v[156:159], v[76:79], v[44:47], v[156:159]
    ds_read_b64_tr_b16 v[66:67], v5 offset:2624
    v_mfma_f32_16x16x32_bf16 v[160:163], v[80:83], v[44:47], v[160:163]
    ds_read_b64_tr_b16 v[68:69], v5 offset:96
    v_mfma_f32_16x16x32_bf16 v[164:167], v[84:87], v[44:47], v[164:167]
    ds_read_b64_tr_b16 v[70:71], v5 offset:2656
    v_mfma_f32_16x16x32_bf16 v[168:171], v[88:91], v[44:47], v[168:171]
    ds_read_b64_tr_b16 v[72:73], v5 offset:128
    v_mfma_f32_16x16x32_bf16 v[172:175], v[92:95], v[44:47], v[172:175]
    ds_read_b64_tr_b16 v[74:75], v5 offset:2688
    ds_read_b128 v[44:47], v2 offset:34816
    v_mfma_f32_16x16x32_bf16 v[196:199], v[76:79], v[48:51], v[196:199]
    v_mfma_f32_16x16x32_bf16 v[200:203], v[80:83], v[48:51], v[200:203]
    v_mfma_f32_16x16x32_bf16 v[204:207], v[84:87], v[48:51], v[204:207]
    v_mfma_f32_16x16x32_bf16 v[208:211], v[88:91], v[48:51], v[208:211]
    v_mfma_f32_16x16x32_bf16 v[212:215], v[92:95], v[48:51], v[212:215]
    ds_read_b128 v[48:51], v2 offset:36864
    v_mfma_f32_16x16x32_bf16 v[236:239], v[76:79], v[52:55], v[236:239]
    v_mfma_f32_16x16x32_bf16 v[240:243], v[80:83], v[52:55], v[240:243]
    v_mfma_f32_16x16x32_bf16 v[244:247], v[84:87], v[52:55], v[244:247]
    v_mfma_f32_16x16x32_bf16 v[248:251], v[88:91], v[52:55], v[248:251]
    v_mfma_f32_16x16x32_bf16 v[252:255], v[92:95], v[52:55], v[252:255]
    ds_read_b128 v[52:55], v2 offset:38912
    ds_read_b64_tr_b16 v[76:77], v5 offset:20480
    ds_read_b64_tr_b16 v[78:79], v5 offset:23040
    ds_read_b64_tr_b16 v[80:81], v5 offset:20512
    ds_read_b64_tr_b16 v[82:83], v5 offset:23072
    ds_read_b64_tr_b16 v[84:85], v5 offset:20544
    ds_read_b64_tr_b16 v[86:87], v5 offset:23104
    ds_read_b64_tr_b16 v[88:89], v5 offset:20576
    ds_read_b64_tr_b16 v[90:91], v5 offset:23136
    ds_read_b64_tr_b16 v[92:93], v5 offset:20608
    ds_read_b64_tr_b16 v[94:95], v5 offset:23168
    s_waitcnt lgkmcnt(13)
    v_mfma_f32_16x16x32_bf16 v[96:99], v[56:59], v[40:43], v[96:99]
    v_mfma_f32_16x16x32_bf16 v[100:103], v[60:63], v[40:43], v[100:103]
    v_mfma_f32_16x16x32_bf16 v[104:107], v[64:67], v[40:43], v[104:107]
    v_mfma_f32_16x16x32_bf16 v[108:111], v[68:71], v[40:43], v[108:111]
    v_mfma_f32_16x16x32_bf16 v[112:115], v[72:75], v[40:43], v[112:115]
    s_waitcnt lgkmcnt(12)
    v_mfma_f32_16x16x32_bf16 v[136:139], v[56:59], v[44:47], v[136:139]
    v_mfma_f32_16x16x32_bf16 v[140:143], v[60:63], v[44:47], v[140:143]
    v_mfma_f32_16x16x32_bf16 v[144:147], v[64:67], v[44:47], v[144:147]
    v_mfma_f32_16x16x32_bf16 v[148:151], v[68:71], v[44:47], v[148:151]
    v_mfma_f32_16x16x32_bf16 v[152:155], v[72:75], v[44:47], v[152:155]
    s_waitcnt lgkmcnt(11)
    v_mfma_f32_16x16x32_bf16 v[176:179], v[56:59], v[48:51], v[176:179]
    v_mfma_f32_16x16x32_bf16 v[180:183], v[60:63], v[48:51], v[180:183]
    v_mfma_f32_16x16x32_bf16 v[184:187], v[64:67], v[48:51], v[184:187]
    v_mfma_f32_16x16x32_bf16 v[188:191], v[68:71], v[48:51], v[188:191]
    v_mfma_f32_16x16x32_bf16 v[192:195], v[72:75], v[48:51], v[192:195]
    s_waitcnt lgkmcnt(10)
    v_mfma_f32_16x16x32_bf16 v[216:219], v[56:59], v[52:55], v[216:219]
    v_mfma_f32_16x16x32_bf16 v[220:223], v[60:63], v[52:55], v[220:223]
    v_mfma_f32_16x16x32_bf16 v[224:227], v[64:67], v[52:55], v[224:227]
    v_mfma_f32_16x16x32_bf16 v[228:231], v[68:71], v[52:55], v[228:231]
    v_mfma_f32_16x16x32_bf16 v[232:235], v[72:75], v[52:55], v[232:235]
    s_waitcnt lgkmcnt(0)
    v_mfma_f32_16x16x32_bf16 v[116:119], v[76:79], v[40:43], v[116:119]
    ds_read_b64_tr_b16 v[56:57], v5 offset:5120
    v_mfma_f32_16x16x32_bf16 v[120:123], v[80:83], v[40:43], v[120:123]
    ds_read_b64_tr_b16 v[58:59], v5 offset:7680
    v_mfma_f32_16x16x32_bf16 v[124:127], v[84:87], v[40:43], v[124:127]
    ds_read_b64_tr_b16 v[60:61], v5 offset:5152
    v_mfma_f32_16x16x32_bf16 v[128:131], v[88:91], v[40:43], v[128:131]
    ds_read_b64_tr_b16 v[62:63], v5 offset:7712
    v_mfma_f32_16x16x32_bf16 v[132:135], v[92:95], v[40:43], v[132:135]
    ds_read_b64_tr_b16 v[64:65], v5 offset:5184
    ds_read_b128 v[40:43], v3 offset:32768
    v_mfma_f32_16x16x32_bf16 v[156:159], v[76:79], v[44:47], v[156:159]
    ds_read_b64_tr_b16 v[66:67], v5 offset:7744
    v_mfma_f32_16x16x32_bf16 v[160:163], v[80:83], v[44:47], v[160:163]
    ds_read_b64_tr_b16 v[68:69], v5 offset:5216
    v_mfma_f32_16x16x32_bf16 v[164:167], v[84:87], v[44:47], v[164:167]
    ds_read_b64_tr_b16 v[70:71], v5 offset:7776
    v_mfma_f32_16x16x32_bf16 v[168:171], v[88:91], v[44:47], v[168:171]
    ds_read_b64_tr_b16 v[72:73], v5 offset:5248
    v_mfma_f32_16x16x32_bf16 v[172:175], v[92:95], v[44:47], v[172:175]
    ds_read_b64_tr_b16 v[74:75], v5 offset:7808
    ds_read_b128 v[44:47], v3 offset:34816
    v_mfma_f32_16x16x32_bf16 v[196:199], v[76:79], v[48:51], v[196:199]
    v_mfma_f32_16x16x32_bf16 v[200:203], v[80:83], v[48:51], v[200:203]
    v_mfma_f32_16x16x32_bf16 v[204:207], v[84:87], v[48:51], v[204:207]
    v_mfma_f32_16x16x32_bf16 v[208:211], v[88:91], v[48:51], v[208:211]
    v_mfma_f32_16x16x32_bf16 v[212:215], v[92:95], v[48:51], v[212:215]
    ds_read_b128 v[48:51], v3 offset:36864
    v_mfma_f32_16x16x32_bf16 v[236:239], v[76:79], v[52:55], v[236:239]
    v_mfma_f32_16x16x32_bf16 v[240:243], v[80:83], v[52:55], v[240:243]
    v_mfma_f32_16x16x32_bf16 v[244:247], v[84:87], v[52:55], v[244:247]
    v_mfma_f32_16x16x32_bf16 v[248:251], v[88:91], v[52:55], v[248:251]
    v_mfma_f32_16x16x32_bf16 v[252:255], v[92:95], v[52:55], v[252:255]
    ds_read_b128 v[52:55], v3 offset:38912
    s_waitcnt lgkmcnt(3)
    v_mfma_f32_16x16x32_bf16 v[96:99], v[56:59], v[40:43], v[96:99]
    ds_read_b64_tr_b16 v[76:77], v5 offset:25600
    v_mfma_f32_16x16x32_bf16 v[100:103], v[60:63], v[40:43], v[100:103]
    ds_read_b64_tr_b16 v[78:79], v5 offset:28160
    v_mfma_f32_16x16x32_bf16 v[104:107], v[64:67], v[40:43], v[104:107]
    ds_read_b64_tr_b16 v[80:81], v5 offset:25632
    v_mfma_f32_16x16x32_bf16 v[108:111], v[68:71], v[40:43], v[108:111]
    ds_read_b64_tr_b16 v[82:83], v5 offset:28192
    v_mfma_f32_16x16x32_bf16 v[112:115], v[72:75], v[40:43], v[112:115]
    ds_read_b64_tr_b16 v[84:85], v5 offset:25664
    s_waitcnt lgkmcnt(7)
    v_mfma_f32_16x16x32_bf16 v[136:139], v[56:59], v[44:47], v[136:139]
    ds_read_b64_tr_b16 v[86:87], v5 offset:28224
    v_mfma_f32_16x16x32_bf16 v[140:143], v[60:63], v[44:47], v[140:143]
    ds_read_b64_tr_b16 v[88:89], v5 offset:25696
    v_mfma_f32_16x16x32_bf16 v[144:147], v[64:67], v[44:47], v[144:147]
    ds_read_b64_tr_b16 v[90:91], v5 offset:28256
    v_mfma_f32_16x16x32_bf16 v[148:151], v[68:71], v[44:47], v[148:151]
    ds_read_b64_tr_b16 v[92:93], v5 offset:25728
    v_mfma_f32_16x16x32_bf16 v[152:155], v[72:75], v[44:47], v[152:155]
    ds_read_b64_tr_b16 v[94:95], v5 offset:28288
    s_waitcnt lgkmcnt(11)
    v_mfma_f32_16x16x32_bf16 v[176:179], v[56:59], v[48:51], v[176:179]
    v_mfma_f32_16x16x32_bf16 v[180:183], v[60:63], v[48:51], v[180:183]
    v_mfma_f32_16x16x32_bf16 v[184:187], v[64:67], v[48:51], v[184:187]
    v_mfma_f32_16x16x32_bf16 v[188:191], v[68:71], v[48:51], v[188:191]
    v_mfma_f32_16x16x32_bf16 v[192:195], v[72:75], v[48:51], v[192:195]
    s_waitcnt lgkmcnt(10)
    v_mfma_f32_16x16x32_bf16 v[216:219], v[56:59], v[52:55], v[216:219]
    v_mfma_f32_16x16x32_bf16 v[220:223], v[60:63], v[52:55], v[220:223]
    v_mfma_f32_16x16x32_bf16 v[224:227], v[64:67], v[52:55], v[224:227]
    v_mfma_f32_16x16x32_bf16 v[228:231], v[68:71], v[52:55], v[228:231]
    v_mfma_f32_16x16x32_bf16 v[232:235], v[72:75], v[52:55], v[232:235]
    s_waitcnt lgkmcnt(0)
    v_mfma_f32_16x16x32_bf16 v[116:119], v[76:79], v[40:43], v[116:119]
    v_mfma_f32_16x16x32_bf16 v[120:123], v[80:83], v[40:43], v[120:123]
    v_mfma_f32_16x16x32_bf16 v[124:127], v[84:87], v[40:43], v[124:127]
    v_mfma_f32_16x16x32_bf16 v[128:131], v[88:91], v[40:43], v[128:131]
    v_mfma_f32_16x16x32_bf16 v[132:135], v[92:95], v[40:43], v[132:135]
    v_mfma_f32_16x16x32_bf16 v[156:159], v[76:79], v[44:47], v[156:159]
    v_mfma_f32_16x16x32_bf16 v[160:163], v[80:83], v[44:47], v[160:163]
    v_mfma_f32_16x16x32_bf16 v[164:167], v[84:87], v[44:47], v[164:167]
    v_mfma_f32_16x16x32_bf16 v[168:171], v[88:91], v[44:47], v[168:171]
    v_mfma_f32_16x16x32_bf16 v[172:175], v[92:95], v[44:47], v[172:175]
    v_mfma_f32_16x16x32_bf16 v[196:199], v[76:79], v[48:51], v[196:199]
    v_mfma_f32_16x16x32_bf16 v[200:203], v[80:83], v[48:51], v[200:203]
    v_mfma_f32_16x16x32_bf16 v[204:207], v[84:87], v[48:51], v[204:207]
    v_mfma_f32_16x16x32_bf16 v[208:211], v[88:91], v[48:51], v[208:211]
    v_mfma_f32_16x16x32_bf16 v[212:215], v[92:95], v[48:51], v[212:215]
    v_mfma_f32_16x16x32_bf16 v[236:239], v[76:79], v[52:55], v[236:239]
    v_mfma_f32_16x16x32_bf16 v[240:243], v[80:83], v[52:55], v[240:243]
    v_mfma_f32_16x16x32_bf16 v[244:247], v[84:87], v[52:55], v[244:247]
    v_mfma_f32_16x16x32_bf16 v[248:251], v[88:91], v[52:55], v[248:251]
    v_mfma_f32_16x16x32_bf16 v[252:255], v[92:95], v[52:55], v[252:255]
    s_nop 7
    s_nop 7
    v_and_b32 v1, 63, v0
    s_mov_b32 s74, 0xbfb8aa3b
    s_load_dwordx2 s[44:45], s[0:1], 72
    s_waitcnt lgkmcnt(0)
    s_cmp_gt_u32 s81, 9
    s_cbranch_scc1 g1_epi_G
    s_cmp_lt_u32 s81, 9
    s_cbranch_scc1 g1_epi_Q
    s_cmp_eq_u32 s28, 1
    s_cbranch_scc1 g1_epi_M1
g1_epi_Q:
    s_add_u32 s16, s44, 0x400000
    s_addc_u32 s17, s45, 0
    s_mov_b32 s18, 0xc00000
    s_mov_b32 s19, 0x00020000
    v_and_b32 v17, 15, v1
    v_lshrrev_b32 v18, 4, v1
    v_mul_u32_u24 v15, 6144, v17
    v_and_b32 v19, 1, v18
    v_lshlrev_b32 v19, 5, v19
    v_add_u32 v15, v15, v19
    v_lshrrev_b32 v19, 1, v18
    v_lshlrev_b32 v19, 4, v19
    v_add_u32 v15, v15, v19
    v_and_b32 v20, 1, v18
    v_lshlrev_b32 v20, 4, v20
    v_add_u32 v20, v20, v17
    v_mul_u32_u24 v16, 6144, v20
    v_add_u32 v16, v16, v19
    s_mul_i32 s46, s80, 6144
    s_mul_i32 s47, s81, 640
    s_add_u32 s46, s46, s47
    s_mul_i32 s47, s28, 320
    s_add_u32 s46, s46, s47
    v_cvt_pk_bf16_f32 v44, v96, v97
    v_cvt_pk_bf16_f32 v45, v98, v99
    v_cvt_pk_bf16_f32 v46, v100, v101
    v_cvt_pk_bf16_f32 v47, v102, v103
    s_add_u32 s47, s46, 0
    s_nop 1
    v_permlane16_swap_b32 v44, v46
    v_permlane16_swap_b32 v45, v47
    s_nop 0
    buffer_store_dwordx4 v[44:47], v15, s[16:19], s47 offen
    v_cvt_pk_bf16_f32 v48, v104, v105
    v_cvt_pk_bf16_f32 v49, v106, v107
    v_cvt_pk_bf16_f32 v50, v108, v109
    v_cvt_pk_bf16_f32 v51, v110, v111
    s_add_u32 s47, s46, 64
    s_nop 1
    v_permlane16_swap_b32 v48, v50
    v_permlane16_swap_b32 v49, v51
    s_nop 0
    buffer_store_dwordx4 v[48:51], v15, s[16:19], s47 offen
    v_cvt_pk_bf16_f32 v52, v112, v113
    v_cvt_pk_bf16_f32 v53, v114, v115
    v_cvt_pk_bf16_f32 v54, v116, v117
    v_cvt_pk_bf16_f32 v55, v118, v119
    s_add_u32 s47, s46, 128
    s_nop 1
    v_permlane16_swap_b32 v52, v54
    v_permlane16_swap_b32 v53, v55
    s_nop 0
    buffer_store_dwordx4 v[52:55], v15, s[16:19], s47 offen
    v_cvt_pk_bf16_f32 v40, v120, v121
    v_cvt_pk_bf16_f32 v41, v122, v123
    v_cvt_pk_bf16_f32 v42, v124, v125
    v_cvt_pk_bf16_f32 v43, v126, v127
    s_add_u32 s47, s46, 192
    s_nop 1
    v_permlane16_swap_b32 v40, v42
    v_permlane16_swap_b32 v41, v43
    s_nop 0
    buffer_store_dwordx4 v[40:43], v15, s[16:19], s47 offen
    v_cvt_pk_bf16_f32 v44, v128, v129
    v_cvt_pk_bf16_f32 v45, v130, v131
    v_cvt_pk_bf16_f32 v46, v132, v133
    v_cvt_pk_bf16_f32 v47, v134, v135
    s_add_u32 s47, s46, 256
    s_nop 1
    v_permlane16_swap_b32 v44, v46
    v_permlane16_swap_b32 v45, v47
    s_nop 0
    buffer_store_dwordx4 v[44:47], v15, s[16:19], s47 offen
    v_cvt_pk_bf16_f32 v48, v136, v137
    v_cvt_pk_bf16_f32 v49, v138, v139
    v_cvt_pk_bf16_f32 v50, v140, v141
    v_cvt_pk_bf16_f32 v51, v142, v143
    s_add_u32 s47, s46, 98304
    s_nop 1
    v_permlane16_swap_b32 v48, v50
    v_permlane16_swap_b32 v49, v51
    s_nop 0
    buffer_store_dwordx4 v[48:51], v15, s[16:19], s47 offen
    v_cvt_pk_bf16_f32 v52, v144, v145
    v_cvt_pk_bf16_f32 v53, v146, v147
    v_cvt_pk_bf16_f32 v54, v148, v149
    v_cvt_pk_bf16_f32 v55, v150, v151
    s_add_u32 s47, s46, 98368
    s_nop 1
    v_permlane16_swap_b32 v52, v54
    v_permlane16_swap_b32 v53, v55
    s_nop 0
    buffer_store_dwordx4 v[52:55], v15, s[16:19], s47 offen
    v_cvt_pk_bf16_f32 v40, v152, v153
    v_cvt_pk_bf16_f32 v41, v154, v155
    v_cvt_pk_bf16_f32 v42, v156, v157
    v_cvt_pk_bf16_f32 v43, v158, v159
    s_add_u32 s47, s46, 98432
    s_nop 1
    v_permlane16_swap_b32 v40, v42
    v_permlane16_swap_b32 v41, v43
    s_nop 0
    buffer_store_dwordx4 v[40:43], v15, s[16:19], s47 offen
    v_cvt_pk_bf16_f32 v44, v160, v161
    v_cvt_pk_bf16_f32 v45, v162, v163
    v_cvt_pk_bf16_f32 v46, v164, v165
    v_cvt_pk_bf16_f32 v47, v166, v167
    s_add_u32 s47, s46, 98496
    s_nop 1
    v_permlane16_swap_b32 v44, v46
    v_permlane16_swap_b32 v45, v47
    s_nop 0
    buffer_store_dwordx4 v[44:47], v15, s[16:19], s47 offen
    v_cvt_pk_bf16_f32 v48, v168, v169
    v_cvt_pk_bf16_f32 v49, v170, v171
    v_cvt_pk_bf16_f32 v50, v172, v173
    v_cvt_pk_bf16_f32 v51, v174, v175
    s_add_u32 s47, s46, 98560
    s_nop 1
    v_permlane16_swap_b32 v48, v50
    v_permlane16_swap_b32 v49, v51
    s_nop 0
    buffer_store_dwordx4 v[48:51], v15, s[16:19], s47 offen
    v_cvt_pk_bf16_f32 v52, v176, v177
    v_cvt_pk_bf16_f32 v53, v178, v179
    v_cvt_pk_bf16_f32 v54, v180, v181
    v_cvt_pk_bf16_f32 v55, v182, v183
    s_add_u32 s47, s46, 196608
    s_nop 1
    v_permlane16_swap_b32 v52, v54
    v_permlane16_swap_b32 v53, v55
    s_nop 0
    buffer_store_dwordx4 v[52:55], v15, s[16:19], s47 offen
    v_cvt_pk_bf16_f32 v40, v184, v185
    v_cvt_pk_bf16_f32 v41, v186, v187
    v_cvt_pk_bf16_f32 v42, v188, v189
    v_cvt_pk_bf16_f32 v43, v190, v191
    s_add_u32 s47, s46, 196672
    s_nop 1
    v_permlane16_swap_b32 v40, v42
    v_permlane16_swap_b32 v41, v43
    s_nop 0
    buffer_store_dwordx4 v[40:43], v15, s[16:19], s47 offen
    v_cvt_pk_bf16_f32 v44, v192, v193
    v_cvt_pk_bf16_f32 v45, v194, v195
    v_cvt_pk_bf16_f32 v46, v196, v197
    v_cvt_pk_bf16_f32 v47, v198, v199
    s_add_u32 s47, s46, 196736
    s_nop 1
    v_permlane16_swap_b32 v44, v46
    v_permlane16_swap_b32 v45, v47
    s_nop 0
    buffer_store_dwordx4 v[44:47], v15, s[16:19], s47 offen
    v_cvt_pk_bf16_f32 v48, v200, v201
    v_cvt_pk_bf16_f32 v49, v202, v203
    v_cvt_pk_bf16_f32 v50, v204, v205
    v_cvt_pk_bf16_f32 v51, v206, v207
    s_add_u32 s47, s46, 196800
    s_nop 1
    v_permlane16_swap_b32 v48, v50
    v_permlane16_swap_b32 v49, v51
    s_nop 0
    buffer_store_dwordx4 v[48:51], v15, s[16:19], s47 offen
    v_cvt_pk_bf16_f32 v52, v208, v209
    v_cvt_pk_bf16_f32 v53, v210, v211
    v_cvt_pk_bf16_f32 v54, v212, v213
    v_cvt_pk_bf16_f32 v55, v214, v215
    s_add_u32 s47, s46, 196864
    s_nop 1
    v_permlane16_swap_b32 v52, v54
    v_permlane16_swap_b32 v53, v55
    s_nop 0
    buffer_store_dwordx4 v[52:55], v15, s[16:19], s47 offen
    v_cvt_pk_bf16_f32 v40, v216, v217
    v_cvt_pk_bf16_f32 v41, v218, v219
    v_cvt_pk_bf16_f32 v42, v220, v221
    v_cvt_pk_bf16_f32 v43, v222, v223
    s_add_u32 s47, s46, 294912
    s_nop 1
    v_permlane16_swap_b32 v40, v42
    v_permlane16_swap_b32 v41, v43
    s_nop 0
    buffer_store_dwordx4 v[40:43], v15, s[16:19], s47 offen
    v_cvt_pk_bf16_f32 v44, v224, v225
    v_cvt_pk_bf16_f32 v45, v226, v227
    v_cvt_pk_bf16_f32 v46, v228, v229
    v_cvt_pk_bf16_f32 v47, v230, v231
    s_add_u32 s47, s46, 294976
    s_nop 1
    v_permlane16_swap_b32 v44, v46
    v_permlane16_swap_b32 v45, v47
    s_nop 0
    buffer_store_dwordx4 v[44:47], v15, s[16:19], s47 offen
    v_cvt_pk_bf16_f32 v48, v232, v233
    v_cvt_pk_bf16_f32 v49, v234, v235
    v_cvt_pk_bf16_f32 v50, v236, v237
    v_cvt_pk_bf16_f32 v51, v238, v239
    s_add_u32 s47, s46, 295040
    s_nop 1
    v_permlane16_swap_b32 v48, v50
    v_permlane16_swap_b32 v49, v51
    s_nop 0
    buffer_store_dwordx4 v[48:51], v15, s[16:19], s47 offen
    v_cvt_pk_bf16_f32 v52, v240, v241
    v_cvt_pk_bf16_f32 v53, v242, v243
    v_cvt_pk_bf16_f32 v54, v244, v245
    v_cvt_pk_bf16_f32 v55, v246, v247
    s_add_u32 s47, s46, 295104
    s_nop 1
    v_permlane16_swap_b32 v52, v54
    v_permlane16_swap_b32 v53, v55
    s_nop 0
    buffer_store_dwordx4 v[52:55], v15, s[16:19], s47 offen
    v_cvt_pk_bf16_f32 v40, v248, v249
    v_cvt_pk_bf16_f32 v41, v250, v251
    v_cvt_pk_bf16_f32 v42, v252, v253
    v_cvt_pk_bf16_f32 v43, v254, v255
    s_add_u32 s47, s46, 295168
    s_nop 1
    v_permlane16_swap_b32 v40, v42
    v_permlane16_swap_b32 v41, v43
    s_nop 0
    buffer_store_dwordx4 v[40:43], v15, s[16:19], s47 offen
    s_branch g1_done
g1_epi_G:
    s_add_u32 s16, s44, 0x1000000
    s_addc_u32 s17, s45, 0
    s_mov_b32 s18, 0xe00000
    s_mov_b32 s19, 0x00020000
    v_and_b32 v17, 15, v1
    v_lshrrev_b32 v18, 4, v1
    v_mul_u32_u24 v15, 7168, v17
    v_and_b32 v19, 1, v18
    v_lshlrev_b32 v19, 5, v19
    v_add_u32 v15, v15, v19
    v_lshrrev_b32 v19, 1, v18
    v_lshlrev_b32 v19, 4, v19
    v_add_u32 v15, v15, v19
    v_and_b32 v20, 1, v18
    v_lshlrev_b32 v20, 4, v20
    v_add_u32 v20, v20, v17
    v_mul_u32_u24 v16, 7168, v20
    v_add_u32 v16, v16, v19
    s_mul_i32 s46, s80, 7168
    s_sub_u32 s47, s81, 10
    s_mul_i32 s47, s47, 320
    s_add_u32 s46, s46, s47
    s_mul_i32 s47, s28, 160
    s_add_u32 s46, s46, s47
    s_add_u32 s46, s46, 128
    v_cvt_pk_bf16_f32 v62, v96, v97
    s_nop 0
    v_lshlrev_b32 v56, 16, v62
    v_and_b32 v57, 0xffff0000, v62
    v_cvt_pk_bf16_f32 v63, v116, v117
    s_nop 0
    v_lshlrev_b32 v58, 16, v63
    v_and_b32 v59, 0xffff0000, v63
    v_mul_f32 v60, s74, v56
    v_mul_f32 v61, s74, v57
    v_exp_f32 v60, v60
    v_exp_f32 v61, v61
    s_nop 0
    v_add_f32 v60, 1.0, v60
    v_add_f32 v61, 1.0, v61
    v_rcp_f32 v60, v60
    v_rcp_f32 v61, v61
    s_nop 0
    v_mul_f32 v60, v56, v60
    v_mul_f32 v61, v57, v61
    v_cvt_pk_bf16_f32 v62, v60, v61
    s_nop 0
    v_lshlrev_b32 v60, 16, v62
    v_and_b32 v61, 0xffff0000, v62
    v_mul_f32 v60, v60, v58
    v_mul_f32 v61, v61, v59
    v_cvt_pk_bf16_f32 v44, v60, v61
    v_cvt_pk_bf16_f32 v62, v98, v99
    s_nop 0
    v_lshlrev_b32 v56, 16, v62
    v_and_b32 v57, 0xffff0000, v62
    v_cvt_pk_bf16_f32 v63, v118, v119
    s_nop 0
    v_lshlrev_b32 v58, 16, v63
    v_and_b32 v59, 0xffff0000, v63
    v_mul_f32 v60, s74, v56
    v_mul_f32 v61, s74, v57
    v_exp_f32 v60, v60
    v_exp_f32 v61, v61
    s_nop 0
    v_add_f32 v60, 1.0, v60
    v_add_f32 v61, 1.0, v61
    v_rcp_f32 v60, v60
    v_rcp_f32 v61, v61
    s_nop 0
    v_mul_f32 v60, v56, v60
    v_mul_f32 v61, v57, v61
    v_cvt_pk_bf16_f32 v62, v60, v61
    s_nop 0
    v_lshlrev_b32 v60, 16, v62
    v_and_b32 v61, 0xffff0000, v62
    v_mul_f32 v60, v60, v58
    v_mul_f32 v61, v61, v59
    v_cvt_pk_bf16_f32 v45, v60, v61
    v_cvt_pk_bf16_f32 v74, v100, v101
    s_nop 0
    v_lshlrev_b32 v68, 16, v74
    v_and_b32 v69, 0xffff0000, v74
    v_cvt_pk_bf16_f32 v75, v120, v121
    s_nop 0
    v_lshlrev_b32 v70, 16, v75
    v_and_b32 v71, 0xffff0000, v75
    v_mul_f32 v72, s74, v68
    v_mul_f32 v73, s74, v69
    v_exp_f32 v72, v72
    v_exp_f32 v73, v73
    s_nop 0
    v_add_f32 v72, 1.0, v72
    v_add_f32 v73, 1.0, v73
    v_rcp_f32 v72, v72
    v_rcp_f32 v73, v73
    s_nop 0
    v_mul_f32 v72, v68, v72
    v_mul_f32 v73, v69, v73
    v_cvt_pk_bf16_f32 v74, v72, v73
    s_nop 0
    v_lshlrev_b32 v72, 16, v74
    v_and_b32 v73, 0xffff0000, v74
    v_mul_f32 v72, v72, v70
    v_mul_f32 v73, v73, v71
    v_cvt_pk_bf16_f32 v46, v72, v73
    v_cvt_pk_bf16_f32 v74, v102, v103
    s_nop 0
    v_lshlrev_b32 v68, 16, v74
    v_and_b32 v69, 0xffff0000, v74
    v_cvt_pk_bf16_f32 v75, v122, v123
    s_nop 0
    v_lshlrev_b32 v70, 16, v75
    v_and_b32 v71, 0xffff0000, v75
    v_mul_f32 v72, s74, v68
    v_mul_f32 v73, s74, v69
    v_exp_f32 v72, v72
    v_exp_f32 v73, v73
    s_nop 0
    v_add_f32 v72, 1.0, v72
    v_add_f32 v73, 1.0, v73
    v_rcp_f32 v72, v72
    v_rcp_f32 v73, v73
    s_nop 0
    v_mul_f32 v72, v68, v72
    v_mul_f32 v73, v69, v73
    v_cvt_pk_bf16_f32 v74, v72, v73
    s_nop 0
    v_lshlrev_b32 v72, 16, v74
    v_and_b32 v73, 0xffff0000, v74
    v_mul_f32 v72, v72, v70
    v_mul_f32 v73, v73, v71
    v_cvt_pk_bf16_f32 v47, v72, v73
    s_add_u32 s47, s46, 0
    s_nop 1
    v_permlane16_swap_b32 v44, v46
    v_permlane16_swap_b32 v45, v47
    s_nop 0
    buffer_store_dwordx4 v[44:47], v15, s[16:19], s47 offen
    v_cvt_pk_bf16_f32 v62, v104, v105
    s_nop 0
    v_lshlrev_b32 v56, 16, v62
    v_and_b32 v57, 0xffff0000, v62
    v_cvt_pk_bf16_f32 v63, v124, v125
    s_nop 0
    v_lshlrev_b32 v58, 16, v63
    v_and_b32 v59, 0xffff0000, v63
    v_mul_f32 v60, s74, v56
    v_mul_f32 v61, s74, v57
    v_exp_f32 v60, v60
    v_exp_f32 v61, v61
    s_nop 0
    v_add_f32 v60, 1.0, v60
    v_add_f32 v61, 1.0, v61
    v_rcp_f32 v60, v60
    v_rcp_f32 v61, v61
    s_nop 0
    v_mul_f32 v60, v56, v60
    v_mul_f32 v61, v57, v61
    v_cvt_pk_bf16_f32 v62, v60, v61
    s_nop 0
    v_lshlrev_b32 v60, 16, v62
    v_and_b32 v61, 0xffff0000, v62
    v_mul_f32 v60, v60, v58
    v_mul_f32 v61, v61, v59
    v_cvt_pk_bf16_f32 v48, v60, v61
    v_cvt_pk_bf16_f32 v62, v106, v107
    s_nop 0
    v_lshlrev_b32 v56, 16, v62
    v_and_b32 v57, 0xffff0000, v62
    v_cvt_pk_bf16_f32 v63, v126, v127
    s_nop 0
    v_lshlrev_b32 v58, 16, v63
    v_and_b32 v59, 0xffff0000, v63
    v_mul_f32 v60, s74, v56
    v_mul_f32 v61, s74, v57
    v_exp_f32 v60, v60
    v_exp_f32 v61, v61
    s_nop 0
    v_add_f32 v60, 1.0, v60
    v_add_f32 v61, 1.0, v61
    v_rcp_f32 v60, v60
    v_rcp_f32 v61, v61
    s_nop 0
    v_mul_f32 v60, v56, v60
    v_mul_f32 v61, v57, v61
    v_cvt_pk_bf16_f32 v62, v60, v61
    s_nop 0
    v_lshlrev_b32 v60, 16, v62
    v_and_b32 v61, 0xffff0000, v62
    v_mul_f32 v60, v60, v58
    v_mul_f32 v61, v61, v59
    v_cvt_pk_bf16_f32 v49, v60, v61
    v_cvt_pk_bf16_f32 v74, v108, v109
    s_nop 0
    v_lshlrev_b32 v68, 16, v74
    v_and_b32 v69, 0xffff0000, v74
    v_cvt_pk_bf16_f32 v75, v128, v129
    s_nop 0
    v_lshlrev_b32 v70, 16, v75
    v_and_b32 v71, 0xffff0000, v75
    v_mul_f32 v72, s74, v68
    v_mul_f32 v73, s74, v69
    v_exp_f32 v72, v72
    v_exp_f32 v73, v73
    s_nop 0
    v_add_f32 v72, 1.0, v72
    v_add_f32 v73, 1.0, v73
    v_rcp_f32 v72, v72
    v_rcp_f32 v73, v73
    s_nop 0
    v_mul_f32 v72, v68, v72
    v_mul_f32 v73, v69, v73
    v_cvt_pk_bf16_f32 v74, v72, v73
    s_nop 0
    v_lshlrev_b32 v72, 16, v74
    v_and_b32 v73, 0xffff0000, v74
    v_mul_f32 v72, v72, v70
    v_mul_f32 v73, v73, v71
    v_cvt_pk_bf16_f32 v50, v72, v73
    v_cvt_pk_bf16_f32 v74, v110, v111
    s_nop 0
    v_lshlrev_b32 v68, 16, v74
    v_and_b32 v69, 0xffff0000, v74
    v_cvt_pk_bf16_f32 v75, v130, v131
    s_nop 0
    v_lshlrev_b32 v70, 16, v75
    v_and_b32 v71, 0xffff0000, v75
    v_mul_f32 v72, s74, v68
    v_mul_f32 v73, s74, v69
    v_exp_f32 v72, v72
    v_exp_f32 v73, v73
    s_nop 0
    v_add_f32 v72, 1.0, v72
    v_add_f32 v73, 1.0, v73
    v_rcp_f32 v72, v72
    v_rcp_f32 v73, v73
    s_nop 0
    v_mul_f32 v72, v68, v72
    v_mul_f32 v73, v69, v73
    v_cvt_pk_bf16_f32 v74, v72, v73
    s_nop 0
    v_lshlrev_b32 v72, 16, v74
    v_and_b32 v73, 0xffff0000, v74
    v_mul_f32 v72, v72, v70
    v_mul_f32 v73, v73, v71
    v_cvt_pk_bf16_f32 v51, v72, v73
    s_add_u32 s47, s46, 64
    s_nop 1
    v_permlane16_swap_b32 v48, v50
    v_permlane16_swap_b32 v49, v51
    s_nop 0
    buffer_store_dwordx4 v[48:51], v15, s[16:19], s47 offen
    v_cvt_pk_bf16_f32 v62, v136, v137
    s_nop 0
    v_lshlrev_b32 v56, 16, v62
    v_and_b32 v57, 0xffff0000, v62
    v_cvt_pk_bf16_f32 v63, v156, v157
    s_nop 0
    v_lshlrev_b32 v58, 16, v63
    v_and_b32 v59, 0xffff0000, v63
    v_mul_f32 v60, s74, v56
    v_mul_f32 v61, s74, v57
    v_exp_f32 v60, v60
    v_exp_f32 v61, v61
    s_nop 0
    v_add_f32 v60, 1.0, v60
    v_add_f32 v61, 1.0, v61
    v_rcp_f32 v60, v60
    v_rcp_f32 v61, v61
    s_nop 0
    v_mul_f32 v60, v56, v60
    v_mul_f32 v61, v57, v61
    v_cvt_pk_bf16_f32 v62, v60, v61
    s_nop 0
    v_lshlrev_b32 v60, 16, v62
    v_and_b32 v61, 0xffff0000, v62
    v_mul_f32 v60, v60, v58
    v_mul_f32 v61, v61, v59
    v_cvt_pk_bf16_f32 v52, v60, v61
    v_cvt_pk_bf16_f32 v62, v138, v139
    s_nop 0
    v_lshlrev_b32 v56, 16, v62
    v_and_b32 v57, 0xffff0000, v62
    v_cvt_pk_bf16_f32 v63, v158, v159
    s_nop 0
    v_lshlrev_b32 v58, 16, v63
    v_and_b32 v59, 0xffff0000, v63
    v_mul_f32 v60, s74, v56
    v_mul_f32 v61, s74, v57
    v_exp_f32 v60, v60
    v_exp_f32 v61, v61
    s_nop 0
    v_add_f32 v60, 1.0, v60
    v_add_f32 v61, 1.0, v61
    v_rcp_f32 v60, v60
    v_rcp_f32 v61, v61
    s_nop 0
    v_mul_f32 v60, v56, v60
    v_mul_f32 v61, v57, v61
    v_cvt_pk_bf16_f32 v62, v60, v61
    s_nop 0
    v_lshlrev_b32 v60, 16, v62
    v_and_b32 v61, 0xffff0000, v62
    v_mul_f32 v60, v60, v58
    v_mul_f32 v61, v61, v59
    v_cvt_pk_bf16_f32 v53, v60, v61
    v_cvt_pk_bf16_f32 v74, v140, v141
    s_nop 0
    v_lshlrev_b32 v68, 16, v74
    v_and_b32 v69, 0xffff0000, v74
    v_cvt_pk_bf16_f32 v75, v160, v161
    s_nop 0
    v_lshlrev_b32 v70, 16, v75
    v_and_b32 v71, 0xffff0000, v75
    v_mul_f32 v72, s74, v68
    v_mul_f32 v73, s74, v69
    v_exp_f32 v72, v72
    v_exp_f32 v73, v73
    s_nop 0
    v_add_f32 v72, 1.0, v72
    v_add_f32 v73, 1.0, v73
    v_rcp_f32 v72, v72
    v_rcp_f32 v73, v73
    s_nop 0
    v_mul_f32 v72, v68, v72
    v_mul_f32 v73, v69, v73
    v_cvt_pk_bf16_f32 v74, v72, v73
    s_nop 0
    v_lshlrev_b32 v72, 16, v74
    v_and_b32 v73, 0xffff0000, v74
    v_mul_f32 v72, v72, v70
    v_mul_f32 v73, v73, v71
    v_cvt_pk_bf16_f32 v54, v72, v73
    v_cvt_pk_bf16_f32 v74, v142, v143
    s_nop 0
    v_lshlrev_b32 v68, 16, v74
    v_and_b32 v69, 0xffff0000, v74
    v_cvt_pk_bf16_f32 v75, v162, v163
    s_nop 0
    v_lshlrev_b32 v70, 16, v75
    v_and_b32 v71, 0xffff0000, v75
    v_mul_f32 v72, s74, v68
    v_mul_f32 v73, s74, v69
    v_exp_f32 v72, v72
    v_exp_f32 v73, v73
    s_nop 0
    v_add_f32 v72, 1.0, v72
    v_add_f32 v73, 1.0, v73
    v_rcp_f32 v72, v72
    v_rcp_f32 v73, v73
    s_nop 0
    v_mul_f32 v72, v68, v72
    v_mul_f32 v73, v69, v73
    v_cvt_pk_bf16_f32 v74, v72, v73
    s_nop 0
    v_lshlrev_b32 v72, 16, v74
    v_and_b32 v73, 0xffff0000, v74
    v_mul_f32 v72, v72, v70
    v_mul_f32 v73, v73, v71
    v_cvt_pk_bf16_f32 v55, v72, v73
    s_add_u32 s47, s46, 114688
    s_nop 1
    v_permlane16_swap_b32 v52, v54
    v_permlane16_swap_b32 v53, v55
    s_nop 0
    buffer_store_dwordx4 v[52:55], v15, s[16:19], s47 offen
    v_cvt_pk_bf16_f32 v62, v144, v145
    s_nop 0
    v_lshlrev_b32 v56, 16, v62
    v_and_b32 v57, 0xffff0000, v62
    v_cvt_pk_bf16_f32 v63, v164, v165
    s_nop 0
    v_lshlrev_b32 v58, 16, v63
    v_and_b32 v59, 0xffff0000, v63
    v_mul_f32 v60, s74, v56
    v_mul_f32 v61, s74, v57
    v_exp_f32 v60, v60
    v_exp_f32 v61, v61
    s_nop 0
    v_add_f32 v60, 1.0, v60
    v_add_f32 v61, 1.0, v61
    v_rcp_f32 v60, v60
    v_rcp_f32 v61, v61
    s_nop 0
    v_mul_f32 v60, v56, v60
    v_mul_f32 v61, v57, v61
    v_cvt_pk_bf16_f32 v62, v60, v61
    s_nop 0
    v_lshlrev_b32 v60, 16, v62
    v_and_b32 v61, 0xffff0000, v62
    v_mul_f32 v60, v60, v58
    v_mul_f32 v61, v61, v59
    v_cvt_pk_bf16_f32 v40, v60, v61
    v_cvt_pk_bf16_f32 v62, v146, v147
    s_nop 0
    v_lshlrev_b32 v56, 16, v62
    v_and_b32 v57, 0xffff0000, v62
    v_cvt_pk_bf16_f32 v63, v166, v167
    s_nop 0
    v_lshlrev_b32 v58, 16, v63
    v_and_b32 v59, 0xffff0000, v63
    v_mul_f32 v60, s74, v56
    v_mul_f32 v61, s74, v57
    v_exp_f32 v60, v60
    v_exp_f32 v61, v61
    s_nop 0
    v_add_f32 v60, 1.0, v60
    v_add_f32 v61, 1.0, v61
    v_rcp_f32 v60, v60
    v_rcp_f32 v61, v61
    s_nop 0
    v_mul_f32 v60, v56, v60
    v_mul_f32 v61, v57, v61
    v_cvt_pk_bf16_f32 v62, v60, v61
    s_nop 0
    v_lshlrev_b32 v60, 16, v62
    v_and_b32 v61, 0xffff0000, v62
    v_mul_f32 v60, v60, v58
    v_mul_f32 v61, v61, v59
    v_cvt_pk_bf16_f32 v41, v60, v61
    v_cvt_pk_bf16_f32 v74, v148, v149
    s_nop 0
    v_lshlrev_b32 v68, 16, v74
    v_and_b32 v69, 0xffff0000, v74
    v_cvt_pk_bf16_f32 v75, v168, v169
    s_nop 0
    v_lshlrev_b32 v70, 16, v75
    v_and_b32 v71, 0xffff0000, v75
    v_mul_f32 v72, s74, v68
    v_mul_f32 v73, s74, v69
    v_exp_f32 v72, v72
    v_exp_f32 v73, v73
    s_nop 0
    v_add_f32 v72, 1.0, v72
    v_add_f32 v73, 1.0, v73
    v_rcp_f32 v72, v72
    v_rcp_f32 v73, v73
    s_nop 0
    v_mul_f32 v72, v68, v72
    v_mul_f32 v73, v69, v73
    v_cvt_pk_bf16_f32 v74, v72, v73
    s_nop 0
    v_lshlrev_b32 v72, 16, v74
    v_and_b32 v73, 0xffff0000, v74
    v_mul_f32 v72, v72, v70
    v_mul_f32 v73, v73, v71
    v_cvt_pk_bf16_f32 v42, v72, v73
    v_cvt_pk_bf16_f32 v74, v150, v151
    s_nop 0
    v_lshlrev_b32 v68, 16, v74
    v_and_b32 v69, 0xffff0000, v74
    v_cvt_pk_bf16_f32 v75, v170, v171
    s_nop 0
    v_lshlrev_b32 v70, 16, v75
    v_and_b32 v71, 0xffff0000, v75
    v_mul_f32 v72, s74, v68
    v_mul_f32 v73, s74, v69
    v_exp_f32 v72, v72
    v_exp_f32 v73, v73
    s_nop 0
    v_add_f32 v72, 1.0, v72
    v_add_f32 v73, 1.0, v73
    v_rcp_f32 v72, v72
    v_rcp_f32 v73, v73
    s_nop 0
    v_mul_f32 v72, v68, v72
    v_mul_f32 v73, v69, v73
    v_cvt_pk_bf16_f32 v74, v72, v73
    s_nop 0
    v_lshlrev_b32 v72, 16, v74
    v_and_b32 v73, 0xffff0000, v74
    v_mul_f32 v72, v72, v70
    v_mul_f32 v73, v73, v71
    v_cvt_pk_bf16_f32 v43, v72, v73
    s_add_u32 s47, s46, 114752
    s_nop 1
    v_permlane16_swap_b32 v40, v42
    v_permlane16_swap_b32 v41, v43
    s_nop 0
    buffer_store_dwordx4 v[40:43], v15, s[16:19], s47 offen
    v_cvt_pk_bf16_f32 v62, v176, v177
    s_nop 0
    v_lshlrev_b32 v56, 16, v62
    v_and_b32 v57, 0xffff0000, v62
    v_cvt_pk_bf16_f32 v63, v196, v197
    s_nop 0
    v_lshlrev_b32 v58, 16, v63
    v_and_b32 v59, 0xffff0000, v63
    v_mul_f32 v60, s74, v56
    v_mul_f32 v61, s74, v57
    v_exp_f32 v60, v60
    v_exp_f32 v61, v61
    s_nop 0
    v_add_f32 v60, 1.0, v60
    v_add_f32 v61, 1.0, v61
    v_rcp_f32 v60, v60
    v_rcp_f32 v61, v61
    s_nop 0
    v_mul_f32 v60, v56, v60
    v_mul_f32 v61, v57, v61
    v_cvt_pk_bf16_f32 v62, v60, v61
    s_nop 0
    v_lshlrev_b32 v60, 16, v62
    v_and_b32 v61, 0xffff0000, v62
    v_mul_f32 v60, v60, v58
    v_mul_f32 v61, v61, v59
    v_cvt_pk_bf16_f32 v44, v60, v61
    v_cvt_pk_bf16_f32 v62, v178, v179
    s_nop 0
    v_lshlrev_b32 v56, 16, v62
    v_and_b32 v57, 0xffff0000, v62
    v_cvt_pk_bf16_f32 v63, v198, v199
    s_nop 0
    v_lshlrev_b32 v58, 16, v63
    v_and_b32 v59, 0xffff0000, v63
    v_mul_f32 v60, s74, v56
    v_mul_f32 v61, s74, v57
    v_exp_f32 v60, v60
    v_exp_f32 v61, v61
    s_nop 0
    v_add_f32 v60, 1.0, v60
    v_add_f32 v61, 1.0, v61
    v_rcp_f32 v60, v60
    v_rcp_f32 v61, v61
    s_nop 0
    v_mul_f32 v60, v56, v60
    v_mul_f32 v61, v57, v61
    v_cvt_pk_bf16_f32 v62, v60, v61
    s_nop 0
    v_lshlrev_b32 v60, 16, v62
    v_and_b32 v61, 0xffff0000, v62
    v_mul_f32 v60, v60, v58
    v_mul_f32 v61, v61, v59
    v_cvt_pk_bf16_f32 v45, v60, v61
    v_cvt_pk_bf16_f32 v74, v180, v181
    s_nop 0
    v_lshlrev_b32 v68, 16, v74
    v_and_b32 v69, 0xffff0000, v74
    v_cvt_pk_bf16_f32 v75, v200, v201
    s_nop 0
    v_lshlrev_b32 v70, 16, v75
    v_and_b32 v71, 0xffff0000, v75
    v_mul_f32 v72, s74, v68
    v_mul_f32 v73, s74, v69
    v_exp_f32 v72, v72
    v_exp_f32 v73, v73
    s_nop 0
    v_add_f32 v72, 1.0, v72
    v_add_f32 v73, 1.0, v73
    v_rcp_f32 v72, v72
    v_rcp_f32 v73, v73
    s_nop 0
    v_mul_f32 v72, v68, v72
    v_mul_f32 v73, v69, v73
    v_cvt_pk_bf16_f32 v74, v72, v73
    s_nop 0
    v_lshlrev_b32 v72, 16, v74
    v_and_b32 v73, 0xffff0000, v74
    v_mul_f32 v72, v72, v70
    v_mul_f32 v73, v73, v71
    v_cvt_pk_bf16_f32 v46, v72, v73
    v_cvt_pk_bf16_f32 v74, v182, v183
    s_nop 0
    v_lshlrev_b32 v68, 16, v74
    v_and_b32 v69, 0xffff0000, v74
    v_cvt_pk_bf16_f32 v75, v202, v203
    s_nop 0
    v_lshlrev_b32 v70, 16, v75
    v_and_b32 v71, 0xffff0000, v75
    v_mul_f32 v72, s74, v68
    v_mul_f32 v73, s74, v69
    v_exp_f32 v72, v72
    v_exp_f32 v73, v73
    s_nop 0
    v_add_f32 v72, 1.0, v72
    v_add_f32 v73, 1.0, v73
    v_rcp_f32 v72, v72
    v_rcp_f32 v73, v73
    s_nop 0
    v_mul_f32 v72, v68, v72
    v_mul_f32 v73, v69, v73
    v_cvt_pk_bf16_f32 v74, v72, v73
    s_nop 0
    v_lshlrev_b32 v72, 16, v74
    v_and_b32 v73, 0xffff0000, v74
    v_mul_f32 v72, v72, v70
    v_mul_f32 v73, v73, v71
    v_cvt_pk_bf16_f32 v47, v72, v73
    s_add_u32 s47, s46, 229376
    s_nop 1
    v_permlane16_swap_b32 v44, v46
    v_permlane16_swap_b32 v45, v47
    s_nop 0
    buffer_store_dwordx4 v[44:47], v15, s[16:19], s47 offen
    v_cvt_pk_bf16_f32 v62, v184, v185
    s_nop 0
    v_lshlrev_b32 v56, 16, v62
    v_and_b32 v57, 0xffff0000, v62
    v_cvt_pk_bf16_f32 v63, v204, v205
    s_nop 0
    v_lshlrev_b32 v58, 16, v63
    v_and_b32 v59, 0xffff0000, v63
    v_mul_f32 v60, s74, v56
    v_mul_f32 v61, s74, v57
    v_exp_f32 v60, v60
    v_exp_f32 v61, v61
    s_nop 0
    v_add_f32 v60, 1.0, v60
    v_add_f32 v61, 1.0, v61
    v_rcp_f32 v60, v60
    v_rcp_f32 v61, v61
    s_nop 0
    v_mul_f32 v60, v56, v60
    v_mul_f32 v61, v57, v61
    v_cvt_pk_bf16_f32 v62, v60, v61
    s_nop 0
    v_lshlrev_b32 v60, 16, v62
    v_and_b32 v61, 0xffff0000, v62
    v_mul_f32 v60, v60, v58
    v_mul_f32 v61, v61, v59
    v_cvt_pk_bf16_f32 v48, v60, v61
    v_cvt_pk_bf16_f32 v62, v186, v187
    s_nop 0
    v_lshlrev_b32 v56, 16, v62
    v_and_b32 v57, 0xffff0000, v62
    v_cvt_pk_bf16_f32 v63, v206, v207
    s_nop 0
    v_lshlrev_b32 v58, 16, v63
    v_and_b32 v59, 0xffff0000, v63
    v_mul_f32 v60, s74, v56
    v_mul_f32 v61, s74, v57
    v_exp_f32 v60, v60
    v_exp_f32 v61, v61
    s_nop 0
    v_add_f32 v60, 1.0, v60
    v_add_f32 v61, 1.0, v61
    v_rcp_f32 v60, v60
    v_rcp_f32 v61, v61
    s_nop 0
    v_mul_f32 v60, v56, v60
    v_mul_f32 v61, v57, v61
    v_cvt_pk_bf16_f32 v62, v60, v61
    s_nop 0
    v_lshlrev_b32 v60, 16, v62
    v_and_b32 v61, 0xffff0000, v62
    v_mul_f32 v60, v60, v58
    v_mul_f32 v61, v61, v59
    v_cvt_pk_bf16_f32 v49, v60, v61
    v_cvt_pk_bf16_f32 v74, v188, v189
    s_nop 0
    v_lshlrev_b32 v68, 16, v74
    v_and_b32 v69, 0xffff0000, v74
    v_cvt_pk_bf16_f32 v75, v208, v209
    s_nop 0
    v_lshlrev_b32 v70, 16, v75
    v_and_b32 v71, 0xffff0000, v75
    v_mul_f32 v72, s74, v68
    v_mul_f32 v73, s74, v69
    v_exp_f32 v72, v72
    v_exp_f32 v73, v73
    s_nop 0
    v_add_f32 v72, 1.0, v72
    v_add_f32 v73, 1.0, v73
    v_rcp_f32 v72, v72
    v_rcp_f32 v73, v73
    s_nop 0
    v_mul_f32 v72, v68, v72
    v_mul_f32 v73, v69, v73
    v_cvt_pk_bf16_f32 v74, v72, v73
    s_nop 0
    v_lshlrev_b32 v72, 16, v74
    v_and_b32 v73, 0xffff0000, v74
    v_mul_f32 v72, v72, v70
    v_mul_f32 v73, v73, v71
    v_cvt_pk_bf16_f32 v50, v72, v73
    v_cvt_pk_bf16_f32 v74, v190, v191
    s_nop 0
    v_lshlrev_b32 v68, 16, v74
    v_and_b32 v69, 0xffff0000, v74
    v_cvt_pk_bf16_f32 v75, v210, v211
    s_nop 0
    v_lshlrev_b32 v70, 16, v75
    v_and_b32 v71, 0xffff0000, v75
    v_mul_f32 v72, s74, v68
    v_mul_f32 v73, s74, v69
    v_exp_f32 v72, v72
    v_exp_f32 v73, v73
    s_nop 0
    v_add_f32 v72, 1.0, v72
    v_add_f32 v73, 1.0, v73
    v_rcp_f32 v72, v72
    v_rcp_f32 v73, v73
    s_nop 0
    v_mul_f32 v72, v68, v72
    v_mul_f32 v73, v69, v73
    v_cvt_pk_bf16_f32 v74, v72, v73
    s_nop 0
    v_lshlrev_b32 v72, 16, v74
    v_and_b32 v73, 0xffff0000, v74
    v_mul_f32 v72, v72, v70
    v_mul_f32 v73, v73, v71
    v_cvt_pk_bf16_f32 v51, v72, v73
    s_add_u32 s47, s46, 229440
    s_nop 1
    v_permlane16_swap_b32 v48, v50
    v_permlane16_swap_b32 v49, v51
    s_nop 0
    buffer_store_dwordx4 v[48:51], v15, s[16:19], s47 offen
    v_cvt_pk_bf16_f32 v62, v216, v217
    s_nop 0
    v_lshlrev_b32 v56, 16, v62
    v_and_b32 v57, 0xffff0000, v62
    v_cvt_pk_bf16_f32 v63, v236, v237
    s_nop 0
    v_lshlrev_b32 v58, 16, v63
    v_and_b32 v59, 0xffff0000, v63
    v_mul_f32 v60, s74, v56
    v_mul_f32 v61, s74, v57
    v_exp_f32 v60, v60
    v_exp_f32 v61, v61
    s_nop 0
    v_add_f32 v60, 1.0, v60
    v_add_f32 v61, 1.0, v61
    v_rcp_f32 v60, v60
    v_rcp_f32 v61, v61
    s_nop 0
    v_mul_f32 v60, v56, v60
    v_mul_f32 v61, v57, v61
    v_cvt_pk_bf16_f32 v62, v60, v61
    s_nop 0
    v_lshlrev_b32 v60, 16, v62
    v_and_b32 v61, 0xffff0000, v62
    v_mul_f32 v60, v60, v58
    v_mul_f32 v61, v61, v59
    v_cvt_pk_bf16_f32 v52, v60, v61
    v_cvt_pk_bf16_f32 v62, v218, v219
    s_nop 0
    v_lshlrev_b32 v56, 16, v62
    v_and_b32 v57, 0xffff0000, v62
    v_cvt_pk_bf16_f32 v63, v238, v239
    s_nop 0
    v_lshlrev_b32 v58, 16, v63
    v_and_b32 v59, 0xffff0000, v63
    v_mul_f32 v60, s74, v56
    v_mul_f32 v61, s74, v57
    v_exp_f32 v60, v60
    v_exp_f32 v61, v61
    s_nop 0
    v_add_f32 v60, 1.0, v60
    v_add_f32 v61, 1.0, v61
    v_rcp_f32 v60, v60
    v_rcp_f32 v61, v61
    s_nop 0
    v_mul_f32 v60, v56, v60
    v_mul_f32 v61, v57, v61
    v_cvt_pk_bf16_f32 v62, v60, v61
    s_nop 0
    v_lshlrev_b32 v60, 16, v62
    v_and_b32 v61, 0xffff0000, v62
    v_mul_f32 v60, v60, v58
    v_mul_f32 v61, v61, v59
    v_cvt_pk_bf16_f32 v53, v60, v61
    v_cvt_pk_bf16_f32 v74, v220, v221
    s_nop 0
    v_lshlrev_b32 v68, 16, v74
    v_and_b32 v69, 0xffff0000, v74
    v_cvt_pk_bf16_f32 v75, v240, v241
    s_nop 0
    v_lshlrev_b32 v70, 16, v75
    v_and_b32 v71, 0xffff0000, v75
    v_mul_f32 v72, s74, v68
    v_mul_f32 v73, s74, v69
    v_exp_f32 v72, v72
    v_exp_f32 v73, v73
    s_nop 0
    v_add_f32 v72, 1.0, v72
    v_add_f32 v73, 1.0, v73
    v_rcp_f32 v72, v72
    v_rcp_f32 v73, v73
    s_nop 0
    v_mul_f32 v72, v68, v72
    v_mul_f32 v73, v69, v73
    v_cvt_pk_bf16_f32 v74, v72, v73
    s_nop 0
    v_lshlrev_b32 v72, 16, v74
    v_and_b32 v73, 0xffff0000, v74
    v_mul_f32 v72, v72, v70
    v_mul_f32 v73, v73, v71
    v_cvt_pk_bf16_f32 v54, v72, v73
    v_cvt_pk_bf16_f32 v74, v222, v223
    s_nop 0
    v_lshlrev_b32 v68, 16, v74
    v_and_b32 v69, 0xffff0000, v74
    v_cvt_pk_bf16_f32 v75, v242, v243
    s_nop 0
    v_lshlrev_b32 v70, 16, v75
    v_and_b32 v71, 0xffff0000, v75
    v_mul_f32 v72, s74, v68
    v_mul_f32 v73, s74, v69
    v_exp_f32 v72, v72
    v_exp_f32 v73, v73
    s_nop 0
    v_add_f32 v72, 1.0, v72
    v_add_f32 v73, 1.0, v73
    v_rcp_f32 v72, v72
    v_rcp_f32 v73, v73
    s_nop 0
    v_mul_f32 v72, v68, v72
    v_mul_f32 v73, v69, v73
    v_cvt_pk_bf16_f32 v74, v72, v73
    s_nop 0
    v_lshlrev_b32 v72, 16, v74
    v_and_b32 v73, 0xffff0000, v74
    v_mul_f32 v72, v72, v70
    v_mul_f32 v73, v73, v71
    v_cvt_pk_bf16_f32 v55, v72, v73
    s_add_u32 s47, s46, 344064
    s_nop 1
    v_permlane16_swap_b32 v52, v54
    v_permlane16_swap_b32 v53, v55
    s_nop 0
    buffer_store_dwordx4 v[52:55], v15, s[16:19], s47 offen
    v_cvt_pk_bf16_f32 v62, v224, v225
    s_nop 0
    v_lshlrev_b32 v56, 16, v62
    v_and_b32 v57, 0xffff0000, v62
    v_cvt_pk_bf16_f32 v63, v244, v245
    s_nop 0
    v_lshlrev_b32 v58, 16, v63
    v_and_b32 v59, 0xffff0000, v63
    v_mul_f32 v60, s74, v56
    v_mul_f32 v61, s74, v57
    v_exp_f32 v60, v60
    v_exp_f32 v61, v61
    s_nop 0
    v_add_f32 v60, 1.0, v60
    v_add_f32 v61, 1.0, v61
    v_rcp_f32 v60, v60
    v_rcp_f32 v61, v61
    s_nop 0
    v_mul_f32 v60, v56, v60
    v_mul_f32 v61, v57, v61
    v_cvt_pk_bf16_f32 v62, v60, v61
    s_nop 0
    v_lshlrev_b32 v60, 16, v62
    v_and_b32 v61, 0xffff0000, v62
    v_mul_f32 v60, v60, v58
    v_mul_f32 v61, v61, v59
    v_cvt_pk_bf16_f32 v40, v60, v61
    v_cvt_pk_bf16_f32 v62, v226, v227
    s_nop 0
    v_lshlrev_b32 v56, 16, v62
    v_and_b32 v57, 0xffff0000, v62
    v_cvt_pk_bf16_f32 v63, v246, v247
    s_nop 0
    v_lshlrev_b32 v58, 16, v63
    v_and_b32 v59, 0xffff0000, v63
    v_mul_f32 v60, s74, v56
    v_mul_f32 v61, s74, v57
    v_exp_f32 v60, v60
    v_exp_f32 v61, v61
    s_nop 0
    v_add_f32 v60, 1.0, v60
    v_add_f32 v61, 1.0, v61
    v_rcp_f32 v60, v60
    v_rcp_f32 v61, v61
    s_nop 0
    v_mul_f32 v60, v56, v60
    v_mul_f32 v61, v57, v61
    v_cvt_pk_bf16_f32 v62, v60, v61
    s_nop 0
    v_lshlrev_b32 v60, 16, v62
    v_and_b32 v61, 0xffff0000, v62
    v_mul_f32 v60, v60, v58
    v_mul_f32 v61, v61, v59
    v_cvt_pk_bf16_f32 v41, v60, v61
    v_cvt_pk_bf16_f32 v74, v228, v229
    s_nop 0
    v_lshlrev_b32 v68, 16, v74
    v_and_b32 v69, 0xffff0000, v74
    v_cvt_pk_bf16_f32 v75, v248, v249
    s_nop 0
    v_lshlrev_b32 v70, 16, v75
    v_and_b32 v71, 0xffff0000, v75
    v_mul_f32 v72, s74, v68
    v_mul_f32 v73, s74, v69
    v_exp_f32 v72, v72
    v_exp_f32 v73, v73
    s_nop 0
    v_add_f32 v72, 1.0, v72
    v_add_f32 v73, 1.0, v73
    v_rcp_f32 v72, v72
    v_rcp_f32 v73, v73
    s_nop 0
    v_mul_f32 v72, v68, v72
    v_mul_f32 v73, v69, v73
    v_cvt_pk_bf16_f32 v74, v72, v73
    s_nop 0
    v_lshlrev_b32 v72, 16, v74
    v_and_b32 v73, 0xffff0000, v74
    v_mul_f32 v72, v72, v70
    v_mul_f32 v73, v73, v71
    v_cvt_pk_bf16_f32 v42, v72, v73
    v_cvt_pk_bf16_f32 v74, v230, v231
    s_nop 0
    v_lshlrev_b32 v68, 16, v74
    v_and_b32 v69, 0xffff0000, v74
    v_cvt_pk_bf16_f32 v75, v250, v251
    s_nop 0
    v_lshlrev_b32 v70, 16, v75
    v_and_b32 v71, 0xffff0000, v75
    v_mul_f32 v72, s74, v68
    v_mul_f32 v73, s74, v69
    v_exp_f32 v72, v72
    v_exp_f32 v73, v73
    s_nop 0
    v_add_f32 v72, 1.0, v72
    v_add_f32 v73, 1.0, v73
    v_rcp_f32 v72, v72
    v_rcp_f32 v73, v73
    s_nop 0
    v_mul_f32 v72, v68, v72
    v_mul_f32 v73, v69, v73
    v_cvt_pk_bf16_f32 v74, v72, v73
    s_nop 0
    v_lshlrev_b32 v72, 16, v74
    v_and_b32 v73, 0xffff0000, v74
    v_mul_f32 v72, v72, v70
    v_mul_f32 v73, v73, v71
    v_cvt_pk_bf16_f32 v43, v72, v73
    s_add_u32 s47, s46, 344128
    s_nop 1
    v_permlane16_swap_b32 v40, v42
    v_permlane16_swap_b32 v41, v43
    s_nop 0
    buffer_store_dwordx4 v[40:43], v15, s[16:19], s47 offen
    v_cvt_pk_bf16_f32 v62, v112, v113
    s_nop 0
    v_lshlrev_b32 v56, 16, v62
    v_and_b32 v57, 0xffff0000, v62
    v_cvt_pk_bf16_f32 v63, v132, v133
    s_nop 0
    v_lshlrev_b32 v58, 16, v63
    v_and_b32 v59, 0xffff0000, v63
    v_mul_f32 v60, s74, v56
    v_mul_f32 v61, s74, v57
    v_exp_f32 v60, v60
    v_exp_f32 v61, v61
    s_nop 0
    v_add_f32 v60, 1.0, v60
    v_add_f32 v61, 1.0, v61
    v_rcp_f32 v60, v60
    v_rcp_f32 v61, v61
    s_nop 0
    v_mul_f32 v60, v56, v60
    v_mul_f32 v61, v57, v61
    v_cvt_pk_bf16_f32 v62, v60, v61
    s_nop 0
    v_lshlrev_b32 v60, 16, v62
    v_and_b32 v61, 0xffff0000, v62
    v_mul_f32 v60, v60, v58
    v_mul_f32 v61, v61, v59
    v_cvt_pk_bf16_f32 v44, v60, v61
    v_cvt_pk_bf16_f32 v62, v114, v115
    s_nop 0
    v_lshlrev_b32 v56, 16, v62
    v_and_b32 v57, 0xffff0000, v62
    v_cvt_pk_bf16_f32 v63, v134, v135
    s_nop 0
    v_lshlrev_b32 v58, 16, v63
    v_and_b32 v59, 0xffff0000, v63
    v_mul_f32 v60, s74, v56
    v_mul_f32 v61, s74, v57
    v_exp_f32 v60, v60
    v_exp_f32 v61, v61
    s_nop 0
    v_add_f32 v60, 1.0, v60
    v_add_f32 v61, 1.0, v61
    v_rcp_f32 v60, v60
    v_rcp_f32 v61, v61
    s_nop 0
    v_mul_f32 v60, v56, v60
    v_mul_f32 v61, v57, v61
    v_cvt_pk_bf16_f32 v62, v60, v61
    s_nop 0
    v_lshlrev_b32 v60, 16, v62
    v_and_b32 v61, 0xffff0000, v62
    v_mul_f32 v60, v60, v58
    v_mul_f32 v61, v61, v59
    v_cvt_pk_bf16_f32 v45, v60, v61
    v_cvt_pk_bf16_f32 v74, v152, v153
    s_nop 0
    v_lshlrev_b32 v68, 16, v74
    v_and_b32 v69, 0xffff0000, v74
    v_cvt_pk_bf16_f32 v75, v172, v173
    s_nop 0
    v_lshlrev_b32 v70, 16, v75
    v_and_b32 v71, 0xffff0000, v75
    v_mul_f32 v72, s74, v68
    v_mul_f32 v73, s74, v69
    v_exp_f32 v72, v72
    v_exp_f32 v73, v73
    s_nop 0
    v_add_f32 v72, 1.0, v72
    v_add_f32 v73, 1.0, v73
    v_rcp_f32 v72, v72
    v_rcp_f32 v73, v73
    s_nop 0
    v_mul_f32 v72, v68, v72
    v_mul_f32 v73, v69, v73
    v_cvt_pk_bf16_f32 v74, v72, v73
    s_nop 0
    v_lshlrev_b32 v72, 16, v74
    v_and_b32 v73, 0xffff0000, v74
    v_mul_f32 v72, v72, v70
    v_mul_f32 v73, v73, v71
    v_cvt_pk_bf16_f32 v46, v72, v73
    v_cvt_pk_bf16_f32 v74, v154, v155
    s_nop 0
    v_lshlrev_b32 v68, 16, v74
    v_and_b32 v69, 0xffff0000, v74
    v_cvt_pk_bf16_f32 v75, v174, v175
    s_nop 0
    v_lshlrev_b32 v70, 16, v75
    v_and_b32 v71, 0xffff0000, v75
    v_mul_f32 v72, s74, v68
    v_mul_f32 v73, s74, v69
    v_exp_f32 v72, v72
    v_exp_f32 v73, v73
    s_nop 0
    v_add_f32 v72, 1.0, v72
    v_add_f32 v73, 1.0, v73
    v_rcp_f32 v72, v72
    v_rcp_f32 v73, v73
    s_nop 0
    v_mul_f32 v72, v68, v72
    v_mul_f32 v73, v69, v73
    v_cvt_pk_bf16_f32 v74, v72, v73
    s_nop 0
    v_lshlrev_b32 v72, 16, v74
    v_and_b32 v73, 0xffff0000, v74
    v_mul_f32 v72, v72, v70
    v_mul_f32 v73, v73, v71
    v_cvt_pk_bf16_f32 v47, v72, v73
    s_add_u32 s47, s46, 128
    s_nop 1
    v_permlane16_swap_b32 v44, v46
    v_permlane16_swap_b32 v45, v47
    s_nop 0
    buffer_store_dwordx4 v[44:47], v16, s[16:19], s47 offen
    v_cvt_pk_bf16_f32 v62, v192, v193
    s_nop 0
    v_lshlrev_b32 v56, 16, v62
    v_and_b32 v57, 0xffff0000, v62
    v_cvt_pk_bf16_f32 v63, v212, v213
    s_nop 0
    v_lshlrev_b32 v58, 16, v63
    v_and_b32 v59, 0xffff0000, v63
    v_mul_f32 v60, s74, v56
    v_mul_f32 v61, s74, v57
    v_exp_f32 v60, v60
    v_exp_f32 v61, v61
    s_nop 0
    v_add_f32 v60, 1.0, v60
    v_add_f32 v61, 1.0, v61
    v_rcp_f32 v60, v60
    v_rcp_f32 v61, v61
    s_nop 0
    v_mul_f32 v60, v56, v60
    v_mul_f32 v61, v57, v61
    v_cvt_pk_bf16_f32 v62, v60, v61
    s_nop 0
    v_lshlrev_b32 v60, 16, v62
    v_and_b32 v61, 0xffff0000, v62
    v_mul_f32 v60, v60, v58
    v_mul_f32 v61, v61, v59
    v_cvt_pk_bf16_f32 v48, v60, v61
    v_cvt_pk_bf16_f32 v62, v194, v195
    s_nop 0
    v_lshlrev_b32 v56, 16, v62
    v_and_b32 v57, 0xffff0000, v62
    v_cvt_pk_bf16_f32 v63, v214, v215
    s_nop 0
    v_lshlrev_b32 v58, 16, v63
    v_and_b32 v59, 0xffff0000, v63
    v_mul_f32 v60, s74, v56
    v_mul_f32 v61, s74, v57
    v_exp_f32 v60, v60
    v_exp_f32 v61, v61
    s_nop 0
    v_add_f32 v60, 1.0, v60
    v_add_f32 v61, 1.0, v61
    v_rcp_f32 v60, v60
    v_rcp_f32 v61, v61
    s_nop 0
    v_mul_f32 v60, v56, v60
    v_mul_f32 v61, v57, v61
    v_cvt_pk_bf16_f32 v62, v60, v61
    s_nop 0
    v_lshlrev_b32 v60, 16, v62
    v_and_b32 v61, 0xffff0000, v62
    v_mul_f32 v60, v60, v58
    v_mul_f32 v61, v61, v59
    v_cvt_pk_bf16_f32 v49, v60, v61
    v_cvt_pk_bf16_f32 v74, v232, v233
    s_nop 0
    v_lshlrev_b32 v68, 16, v74
    v_and_b32 v69, 0xffff0000, v74
    v_cvt_pk_bf16_f32 v75, v252, v253
    s_nop 0
    v_lshlrev_b32 v70, 16, v75
    v_and_b32 v71, 0xffff0000, v75
    v_mul_f32 v72, s74, v68
    v_mul_f32 v73, s74, v69
    v_exp_f32 v72, v72
    v_exp_f32 v73, v73
    s_nop 0
    v_add_f32 v72, 1.0, v72
    v_add_f32 v73, 1.0, v73
    v_rcp_f32 v72, v72
    v_rcp_f32 v73, v73
    s_nop 0
    v_mul_f32 v72, v68, v72
    v_mul_f32 v73, v69, v73
    v_cvt_pk_bf16_f32 v74, v72, v73
    s_nop 0
    v_lshlrev_b32 v72, 16, v74
    v_and_b32 v73, 0xffff0000, v74
    v_mul_f32 v72, v72, v70
    v_mul_f32 v73, v73, v71
    v_cvt_pk_bf16_f32 v50, v72, v73
    v_cvt_pk_bf16_f32 v74, v234, v235
    s_nop 0
    v_lshlrev_b32 v68, 16, v74
    v_and_b32 v69, 0xffff0000, v74
    v_cvt_pk_bf16_f32 v75, v254, v255
    s_nop 0
    v_lshlrev_b32 v70, 16, v75
    v_and_b32 v71, 0xffff0000, v75
    v_mul_f32 v72, s74, v68
    v_mul_f32 v73, s74, v69
    v_exp_f32 v72, v72
    v_exp_f32 v73, v73
    s_nop 0
    v_add_f32 v72, 1.0, v72
    v_add_f32 v73, 1.0, v73
    v_rcp_f32 v72, v72
    v_rcp_f32 v73, v73
    s_nop 0
    v_mul_f32 v72, v68, v72
    v_mul_f32 v73, v69, v73
    v_cvt_pk_bf16_f32 v74, v72, v73
    s_nop 0
    v_lshlrev_b32 v72, 16, v74
    v_and_b32 v73, 0xffff0000, v74
    v_mul_f32 v72, v72, v70
    v_mul_f32 v73, v73, v71
    v_cvt_pk_bf16_f32 v51, v72, v73
    s_add_u32 s47, s46, 229504
    s_nop 1
    v_permlane16_swap_b32 v48, v50
    v_permlane16_swap_b32 v49, v51
    s_nop 0
    buffer_store_dwordx4 v[48:51], v16, s[16:19], s47 offen
    s_branch g1_done
g1_epi_M1:
    s_add_u32 s16, s44, 0x400000
    s_addc_u32 s17, s45, 0
    s_mov_b32 s18, 0xc00000
    s_mov_b32 s19, 0x00020000
    v_and_b32 v17, 15, v1
    v_lshrrev_b32 v18, 4, v1
    v_mul_u32_u24 v15, 6144, v17
    v_and_b32 v19, 1, v18
    v_lshlrev_b32 v19, 5, v19
    v_add_u32 v15, v15, v19
    v_lshrrev_b32 v19, 1, v18
    v_lshlrev_b32 v19, 4, v19
    v_add_u32 v15, v15, v19
    v_and_b32 v20, 1, v18
    v_lshlrev_b32 v20, 4, v20
    v_add_u32 v20, v20, v17
    v_mul_u32_u24 v16, 6144, v20
    v_add_u32 v16, v16, v19
    s_mul_i32 s46, s80, 6144
    s_add_u32 s46, s46, 6080
    v_cvt_pk_bf16_f32 v52, v96, v97
    v_cvt_pk_bf16_f32 v53, v98, v99
    v_cvt_pk_bf16_f32 v54, v116, v117
    v_cvt_pk_bf16_f32 v55, v118, v119
    s_add_u32 s47, s46, 0
    s_nop 1
    v_permlane16_swap_b32 v52, v54
    v_permlane16_swap_b32 v53, v55
    s_nop 0
    buffer_store_dwordx4 v[52:55], v15, s[16:19], s47 offen
    v_cvt_pk_bf16_f32 v40, v136, v137
    v_cvt_pk_bf16_f32 v41, v138, v139
    v_cvt_pk_bf16_f32 v42, v156, v157
    v_cvt_pk_bf16_f32 v43, v158, v159
    s_add_u32 s47, s46, 98304
    s_nop 1
    v_permlane16_swap_b32 v40, v42
    v_permlane16_swap_b32 v41, v43
    s_nop 0
    buffer_store_dwordx4 v[40:43], v15, s[16:19], s47 offen
    v_cvt_pk_bf16_f32 v44, v176, v177
    v_cvt_pk_bf16_f32 v45, v178, v179
    v_cvt_pk_bf16_f32 v46, v196, v197
    v_cvt_pk_bf16_f32 v47, v198, v199
    s_add_u32 s47, s46, 196608
    s_nop 1
    v_permlane16_swap_b32 v44, v46
    v_permlane16_swap_b32 v45, v47
    s_nop 0
    buffer_store_dwordx4 v[44:47], v15, s[16:19], s47 offen
    v_cvt_pk_bf16_f32 v48, v216, v217
    v_cvt_pk_bf16_f32 v49, v218, v219
    v_cvt_pk_bf16_f32 v50, v236, v237
    v_cvt_pk_bf16_f32 v51, v238, v239
    s_add_u32 s47, s46, 294912
    s_nop 1
    v_permlane16_swap_b32 v48, v50
    v_permlane16_swap_b32 v49, v51
    s_nop 0
    buffer_store_dwordx4 v[48:51], v15, s[16:19], s47 offen
    s_waitcnt vmcnt(0)
    s_add_u32 s16, s44, 0x1000000
    s_addc_u32 s17, s45, 0
    s_mov_b32 s18, 0xe00000
    s_mov_b32 s19, 0x00020000
    v_and_b32 v17, 15, v1
    v_lshrrev_b32 v18, 4, v1
    v_mul_u32_u24 v15, 7168, v17
    v_and_b32 v19, 1, v18
    v_lshlrev_b32 v19, 5, v19
    v_add_u32 v15, v15, v19
    v_lshrrev_b32 v19, 1, v18
    v_lshlrev_b32 v19, 4, v19
    v_add_u32 v15, v15, v19
    v_and_b32 v20, 1, v18
    v_lshlrev_b32 v20, 4, v20
    v_add_u32 v20, v20, v17
    v_mul_u32_u24 v16, 7168, v20
    v_add_u32 v16, v16, v19
    s_mul_i32 s46, s80, 7168
    v_cvt_pk_bf16_f32 v62, v100, v101
    s_nop 0
    v_lshlrev_b32 v56, 16, v62
    v_and_b32 v57, 0xffff0000, v62
    v_cvt_pk_bf16_f32 v63, v120, v121
    s_nop 0
    v_lshlrev_b32 v58, 16, v63
    v_and_b32 v59, 0xffff0000, v63
    v_mul_f32 v60, s74, v56
    v_mul_f32 v61, s74, v57
    v_exp_f32 v60, v60
    v_exp_f32 v61, v61
    s_nop 0
    v_add_f32 v60, 1.0, v60
    v_add_f32 v61, 1.0, v61
    v_rcp_f32 v60, v60
    v_rcp_f32 v61, v61
    s_nop 0
    v_mul_f32 v60, v56, v60
    v_mul_f32 v61, v57, v61
    v_cvt_pk_bf16_f32 v62, v60, v61
    s_nop 0
    v_lshlrev_b32 v60, 16, v62
    v_and_b32 v61, 0xffff0000, v62
    v_mul_f32 v60, v60, v58
    v_mul_f32 v61, v61, v59
    v_cvt_pk_bf16_f32 v52, v60, v61
    v_cvt_pk_bf16_f32 v62, v102, v103
    s_nop 0
    v_lshlrev_b32 v56, 16, v62
    v_and_b32 v57, 0xffff0000, v62
    v_cvt_pk_bf16_f32 v63, v122, v123
    s_nop 0
    v_lshlrev_b32 v58, 16, v63
    v_and_b32 v59, 0xffff0000, v63
    v_mul_f32 v60, s74, v56
    v_mul_f32 v61, s74, v57
    v_exp_f32 v60, v60
    v_exp_f32 v61, v61
    s_nop 0
    v_add_f32 v60, 1.0, v60
    v_add_f32 v61, 1.0, v61
    v_rcp_f32 v60, v60
    v_rcp_f32 v61, v61
    s_nop 0
    v_mul_f32 v60, v56, v60
    v_mul_f32 v61, v57, v61
    v_cvt_pk_bf16_f32 v62, v60, v61
    s_nop 0
    v_lshlrev_b32 v60, 16, v62
    v_and_b32 v61, 0xffff0000, v62
    v_mul_f32 v60, v60, v58
    v_mul_f32 v61, v61, v59
    v_cvt_pk_bf16_f32 v53, v60, v61
    v_cvt_pk_bf16_f32 v74, v104, v105
    s_nop 0
    v_lshlrev_b32 v68, 16, v74
    v_and_b32 v69, 0xffff0000, v74
    v_cvt_pk_bf16_f32 v75, v124, v125
    s_nop 0
    v_lshlrev_b32 v70, 16, v75
    v_and_b32 v71, 0xffff0000, v75
    v_mul_f32 v72, s74, v68
    v_mul_f32 v73, s74, v69
    v_exp_f32 v72, v72
    v_exp_f32 v73, v73
    s_nop 0
    v_add_f32 v72, 1.0, v72
    v_add_f32 v73, 1.0, v73
    v_rcp_f32 v72, v72
    v_rcp_f32 v73, v73
    s_nop 0
    v_mul_f32 v72, v68, v72
    v_mul_f32 v73, v69, v73
    v_cvt_pk_bf16_f32 v74, v72, v73
    s_nop 0
    v_lshlrev_b32 v72, 16, v74
    v_and_b32 v73, 0xffff0000, v74
    v_mul_f32 v72, v72, v70
    v_mul_f32 v73, v73, v71
    v_cvt_pk_bf16_f32 v54, v72, v73
    v_cvt_pk_bf16_f32 v74, v106, v107
    s_nop 0
    v_lshlrev_b32 v68, 16, v74
    v_and_b32 v69, 0xffff0000, v74
    v_cvt_pk_bf16_f32 v75, v126, v127
    s_nop 0
    v_lshlrev_b32 v70, 16, v75
    v_and_b32 v71, 0xffff0000, v75
    v_mul_f32 v72, s74, v68
    v_mul_f32 v73, s74, v69
    v_exp_f32 v72, v72
    v_exp_f32 v73, v73
    s_nop 0
    v_add_f32 v72, 1.0, v72
    v_add_f32 v73, 1.0, v73
    v_rcp_f32 v72, v72
    v_rcp_f32 v73, v73
    s_nop 0
    v_mul_f32 v72, v68, v72
    v_mul_f32 v73, v69, v73
    v_cvt_pk_bf16_f32 v74, v72, v73
    s_nop 0
    v_lshlrev_b32 v72, 16, v74
    v_and_b32 v73, 0xffff0000, v74
    v_mul_f32 v72, v72, v70
    v_mul_f32 v73, v73, v71
    v_cvt_pk_bf16_f32 v55, v72, v73
    s_add_u32 s47, s46, 0
    s_nop 1
    v_permlane16_swap_b32 v52, v54
    v_permlane16_swap_b32 v53, v55
    s_nop 0
    buffer_store_dwordx4 v[52:55], v15, s[16:19], s47 offen
    v_cvt_pk_bf16_f32 v62, v108, v109
    s_nop 0
    v_lshlrev_b32 v56, 16, v62
    v_and_b32 v57, 0xffff0000, v62
    v_cvt_pk_bf16_f32 v63, v128, v129
    s_nop 0
    v_lshlrev_b32 v58, 16, v63
    v_and_b32 v59, 0xffff0000, v63
    v_mul_f32 v60, s74, v56
    v_mul_f32 v61, s74, v57
    v_exp_f32 v60, v60
    v_exp_f32 v61, v61
    s_nop 0
    v_add_f32 v60, 1.0, v60
    v_add_f32 v61, 1.0, v61
    v_rcp_f32 v60, v60
    v_rcp_f32 v61, v61
    s_nop 0
    v_mul_f32 v60, v56, v60
    v_mul_f32 v61, v57, v61
    v_cvt_pk_bf16_f32 v62, v60, v61
    s_nop 0
    v_lshlrev_b32 v60, 16, v62
    v_and_b32 v61, 0xffff0000, v62
    v_mul_f32 v60, v60, v58
    v_mul_f32 v61, v61, v59
    v_cvt_pk_bf16_f32 v40, v60, v61
    v_cvt_pk_bf16_f32 v62, v110, v111
    s_nop 0
    v_lshlrev_b32 v56, 16, v62
    v_and_b32 v57, 0xffff0000, v62
    v_cvt_pk_bf16_f32 v63, v130, v131
    s_nop 0
    v_lshlrev_b32 v58, 16, v63
    v_and_b32 v59, 0xffff0000, v63
    v_mul_f32 v60, s74, v56
    v_mul_f32 v61, s74, v57
    v_exp_f32 v60, v60
    v_exp_f32 v61, v61
    s_nop 0
    v_add_f32 v60, 1.0, v60
    v_add_f32 v61, 1.0, v61
    v_rcp_f32 v60, v60
    v_rcp_f32 v61, v61
    s_nop 0
    v_mul_f32 v60, v56, v60
    v_mul_f32 v61, v57, v61
    v_cvt_pk_bf16_f32 v62, v60, v61
    s_nop 0
    v_lshlrev_b32 v60, 16, v62
    v_and_b32 v61, 0xffff0000, v62
    v_mul_f32 v60, v60, v58
    v_mul_f32 v61, v61, v59
    v_cvt_pk_bf16_f32 v41, v60, v61
    v_cvt_pk_bf16_f32 v74, v112, v113
    s_nop 0
    v_lshlrev_b32 v68, 16, v74
    v_and_b32 v69, 0xffff0000, v74
    v_cvt_pk_bf16_f32 v75, v132, v133
    s_nop 0
    v_lshlrev_b32 v70, 16, v75
    v_and_b32 v71, 0xffff0000, v75
    v_mul_f32 v72, s74, v68
    v_mul_f32 v73, s74, v69
    v_exp_f32 v72, v72
    v_exp_f32 v73, v73
    s_nop 0
    v_add_f32 v72, 1.0, v72
    v_add_f32 v73, 1.0, v73
    v_rcp_f32 v72, v72
    v_rcp_f32 v73, v73
    s_nop 0
    v_mul_f32 v72, v68, v72
    v_mul_f32 v73, v69, v73
    v_cvt_pk_bf16_f32 v74, v72, v73
    s_nop 0
    v_lshlrev_b32 v72, 16, v74
    v_and_b32 v73, 0xffff0000, v74
    v_mul_f32 v72, v72, v70
    v_mul_f32 v73, v73, v71
    v_cvt_pk_bf16_f32 v42, v72, v73
    v_cvt_pk_bf16_f32 v74, v114, v115
    s_nop 0
    v_lshlrev_b32 v68, 16, v74
    v_and_b32 v69, 0xffff0000, v74
    v_cvt_pk_bf16_f32 v75, v134, v135
    s_nop 0
    v_lshlrev_b32 v70, 16, v75
    v_and_b32 v71, 0xffff0000, v75
    v_mul_f32 v72, s74, v68
    v_mul_f32 v73, s74, v69
    v_exp_f32 v72, v72
    v_exp_f32 v73, v73
    s_nop 0
    v_add_f32 v72, 1.0, v72
    v_add_f32 v73, 1.0, v73
    v_rcp_f32 v72, v72
    v_rcp_f32 v73, v73
    s_nop 0
    v_mul_f32 v72, v68, v72
    v_mul_f32 v73, v69, v73
    v_cvt_pk_bf16_f32 v74, v72, v73
    s_nop 0
    v_lshlrev_b32 v72, 16, v74
    v_and_b32 v73, 0xffff0000, v74
    v_mul_f32 v72, v72, v70
    v_mul_f32 v73, v73, v71
    v_cvt_pk_bf16_f32 v43, v72, v73
    s_add_u32 s47, s46, 64
    s_nop 1
    v_permlane16_swap_b32 v40, v42
    v_permlane16_swap_b32 v41, v43
    s_nop 0
    buffer_store_dwordx4 v[40:43], v15, s[16:19], s47 offen
    v_cvt_pk_bf16_f32 v62, v140, v141
    s_nop 0
    v_lshlrev_b32 v56, 16, v62
    v_and_b32 v57, 0xffff0000, v62
    v_cvt_pk_bf16_f32 v63, v160, v161
    s_nop 0
    v_lshlrev_b32 v58, 16, v63
    v_and_b32 v59, 0xffff0000, v63
    v_mul_f32 v60, s74, v56
    v_mul_f32 v61, s74, v57
    v_exp_f32 v60, v60
    v_exp_f32 v61, v61
    s_nop 0
    v_add_f32 v60, 1.0, v60
    v_add_f32 v61, 1.0, v61
    v_rcp_f32 v60, v60
    v_rcp_f32 v61, v61
    s_nop 0
    v_mul_f32 v60, v56, v60
    v_mul_f32 v61, v57, v61
    v_cvt_pk_bf16_f32 v62, v60, v61
    s_nop 0
    v_lshlrev_b32 v60, 16, v62
    v_and_b32 v61, 0xffff0000, v62
    v_mul_f32 v60, v60, v58
    v_mul_f32 v61, v61, v59
    v_cvt_pk_bf16_f32 v44, v60, v61
    v_cvt_pk_bf16_f32 v62, v142, v143
    s_nop 0
    v_lshlrev_b32 v56, 16, v62
    v_and_b32 v57, 0xffff0000, v62
    v_cvt_pk_bf16_f32 v63, v162, v163
    s_nop 0
    v_lshlrev_b32 v58, 16, v63
    v_and_b32 v59, 0xffff0000, v63
    v_mul_f32 v60, s74, v56
    v_mul_f32 v61, s74, v57
    v_exp_f32 v60, v60
    v_exp_f32 v61, v61
    s_nop 0
    v_add_f32 v60, 1.0, v60
    v_add_f32 v61, 1.0, v61
    v_rcp_f32 v60, v60
    v_rcp_f32 v61, v61
    s_nop 0
    v_mul_f32 v60, v56, v60
    v_mul_f32 v61, v57, v61
    v_cvt_pk_bf16_f32 v62, v60, v61
    s_nop 0
    v_lshlrev_b32 v60, 16, v62
    v_and_b32 v61, 0xffff0000, v62
    v_mul_f32 v60, v60, v58
    v_mul_f32 v61, v61, v59
    v_cvt_pk_bf16_f32 v45, v60, v61
    v_cvt_pk_bf16_f32 v74, v144, v145
    s_nop 0
    v_lshlrev_b32 v68, 16, v74
    v_and_b32 v69, 0xffff0000, v74
    v_cvt_pk_bf16_f32 v75, v164, v165
    s_nop 0
    v_lshlrev_b32 v70, 16, v75
    v_and_b32 v71, 0xffff0000, v75
    v_mul_f32 v72, s74, v68
    v_mul_f32 v73, s74, v69
    v_exp_f32 v72, v72
    v_exp_f32 v73, v73
    s_nop 0
    v_add_f32 v72, 1.0, v72
    v_add_f32 v73, 1.0, v73
    v_rcp_f32 v72, v72
    v_rcp_f32 v73, v73
    s_nop 0
    v_mul_f32 v72, v68, v72
    v_mul_f32 v73, v69, v73
    v_cvt_pk_bf16_f32 v74, v72, v73
    s_nop 0
    v_lshlrev_b32 v72, 16, v74
    v_and_b32 v73, 0xffff0000, v74
    v_mul_f32 v72, v72, v70
    v_mul_f32 v73, v73, v71
    v_cvt_pk_bf16_f32 v46, v72, v73
    v_cvt_pk_bf16_f32 v74, v146, v147
    s_nop 0
    v_lshlrev_b32 v68, 16, v74
    v_and_b32 v69, 0xffff0000, v74
    v_cvt_pk_bf16_f32 v75, v166, v167
    s_nop 0
    v_lshlrev_b32 v70, 16, v75
    v_and_b32 v71, 0xffff0000, v75
    v_mul_f32 v72, s74, v68
    v_mul_f32 v73, s74, v69
    v_exp_f32 v72, v72
    v_exp_f32 v73, v73
    s_nop 0
    v_add_f32 v72, 1.0, v72
    v_add_f32 v73, 1.0, v73
    v_rcp_f32 v72, v72
    v_rcp_f32 v73, v73
    s_nop 0
    v_mul_f32 v72, v68, v72
    v_mul_f32 v73, v69, v73
    v_cvt_pk_bf16_f32 v74, v72, v73
    s_nop 0
    v_lshlrev_b32 v72, 16, v74
    v_and_b32 v73, 0xffff0000, v74
    v_mul_f32 v72, v72, v70
    v_mul_f32 v73, v73, v71
    v_cvt_pk_bf16_f32 v47, v72, v73
    s_add_u32 s47, s46, 114688
    s_nop 1
    v_permlane16_swap_b32 v44, v46
    v_permlane16_swap_b32 v45, v47
    s_nop 0
    buffer_store_dwordx4 v[44:47], v15, s[16:19], s47 offen
    v_cvt_pk_bf16_f32 v62, v148, v149
    s_nop 0
    v_lshlrev_b32 v56, 16, v62
    v_and_b32 v57, 0xffff0000, v62
    v_cvt_pk_bf16_f32 v63, v168, v169
    s_nop 0
    v_lshlrev_b32 v58, 16, v63
    v_and_b32 v59, 0xffff0000, v63
    v_mul_f32 v60, s74, v56
    v_mul_f32 v61, s74, v57
    v_exp_f32 v60, v60
    v_exp_f32 v61, v61
    s_nop 0
    v_add_f32 v60, 1.0, v60
    v_add_f32 v61, 1.0, v61
    v_rcp_f32 v60, v60
    v_rcp_f32 v61, v61
    s_nop 0
    v_mul_f32 v60, v56, v60
    v_mul_f32 v61, v57, v61
    v_cvt_pk_bf16_f32 v62, v60, v61
    s_nop 0
    v_lshlrev_b32 v60, 16, v62
    v_and_b32 v61, 0xffff0000, v62
    v_mul_f32 v60, v60, v58
    v_mul_f32 v61, v61, v59
    v_cvt_pk_bf16_f32 v48, v60, v61
    v_cvt_pk_bf16_f32 v62, v150, v151
    s_nop 0
    v_lshlrev_b32 v56, 16, v62
    v_and_b32 v57, 0xffff0000, v62
    v_cvt_pk_bf16_f32 v63, v170, v171
    s_nop 0
    v_lshlrev_b32 v58, 16, v63
    v_and_b32 v59, 0xffff0000, v63
    v_mul_f32 v60, s74, v56
    v_mul_f32 v61, s74, v57
    v_exp_f32 v60, v60
    v_exp_f32 v61, v61
    s_nop 0
    v_add_f32 v60, 1.0, v60
    v_add_f32 v61, 1.0, v61
    v_rcp_f32 v60, v60
    v_rcp_f32 v61, v61
    s_nop 0
    v_mul_f32 v60, v56, v60
    v_mul_f32 v61, v57, v61
    v_cvt_pk_bf16_f32 v62, v60, v61
    s_nop 0
    v_lshlrev_b32 v60, 16, v62
    v_and_b32 v61, 0xffff0000, v62
    v_mul_f32 v60, v60, v58
    v_mul_f32 v61, v61, v59
    v_cvt_pk_bf16_f32 v49, v60, v61
    v_cvt_pk_bf16_f32 v74, v152, v153
    s_nop 0
    v_lshlrev_b32 v68, 16, v74
    v_and_b32 v69, 0xffff0000, v74
    v_cvt_pk_bf16_f32 v75, v172, v173
    s_nop 0
    v_lshlrev_b32 v70, 16, v75
    v_and_b32 v71, 0xffff0000, v75
    v_mul_f32 v72, s74, v68
    v_mul_f32 v73, s74, v69
    v_exp_f32 v72, v72
    v_exp_f32 v73, v73
    s_nop 0
    v_add_f32 v72, 1.0, v72
    v_add_f32 v73, 1.0, v73
    v_rcp_f32 v72, v72
    v_rcp_f32 v73, v73
    s_nop 0
    v_mul_f32 v72, v68, v72
    v_mul_f32 v73, v69, v73
    v_cvt_pk_bf16_f32 v74, v72, v73
    s_nop 0
    v_lshlrev_b32 v72, 16, v74
    v_and_b32 v73, 0xffff0000, v74
    v_mul_f32 v72, v72, v70
    v_mul_f32 v73, v73, v71
    v_cvt_pk_bf16_f32 v50, v72, v73
    v_cvt_pk_bf16_f32 v74, v154, v155
    s_nop 0
    v_lshlrev_b32 v68, 16, v74
    v_and_b32 v69, 0xffff0000, v74
    v_cvt_pk_bf16_f32 v75, v174, v175
    s_nop 0
    v_lshlrev_b32 v70, 16, v75
    v_and_b32 v71, 0xffff0000, v75
    v_mul_f32 v72, s74, v68
    v_mul_f32 v73, s74, v69
    v_exp_f32 v72, v72
    v_exp_f32 v73, v73
    s_nop 0
    v_add_f32 v72, 1.0, v72
    v_add_f32 v73, 1.0, v73
    v_rcp_f32 v72, v72
    v_rcp_f32 v73, v73
    s_nop 0
    v_mul_f32 v72, v68, v72
    v_mul_f32 v73, v69, v73
    v_cvt_pk_bf16_f32 v74, v72, v73
    s_nop 0
    v_lshlrev_b32 v72, 16, v74
    v_and_b32 v73, 0xffff0000, v74
    v_mul_f32 v72, v72, v70
    v_mul_f32 v73, v73, v71
    v_cvt_pk_bf16_f32 v51, v72, v73
    s_add_u32 s47, s46, 114752
    s_nop 1
    v_permlane16_swap_b32 v48, v50
    v_permlane16_swap_b32 v49, v51
    s_nop 0
    buffer_store_dwordx4 v[48:51], v15, s[16:19], s47 offen
    v_cvt_pk_bf16_f32 v62, v180, v181
    s_nop 0
    v_lshlrev_b32 v56, 16, v62
    v_and_b32 v57, 0xffff0000, v62
    v_cvt_pk_bf16_f32 v63, v200, v201
    s_nop 0
    v_lshlrev_b32 v58, 16, v63
    v_and_b32 v59, 0xffff0000, v63
    v_mul_f32 v60, s74, v56
    v_mul_f32 v61, s74, v57
    v_exp_f32 v60, v60
    v_exp_f32 v61, v61
    s_nop 0
    v_add_f32 v60, 1.0, v60
    v_add_f32 v61, 1.0, v61
    v_rcp_f32 v60, v60
    v_rcp_f32 v61, v61
    s_nop 0
    v_mul_f32 v60, v56, v60
    v_mul_f32 v61, v57, v61
    v_cvt_pk_bf16_f32 v62, v60, v61
    s_nop 0
    v_lshlrev_b32 v60, 16, v62
    v_and_b32 v61, 0xffff0000, v62
    v_mul_f32 v60, v60, v58
    v_mul_f32 v61, v61, v59
    v_cvt_pk_bf16_f32 v52, v60, v61
    v_cvt_pk_bf16_f32 v62, v182, v183
    s_nop 0
    v_lshlrev_b32 v56, 16, v62
    v_and_b32 v57, 0xffff0000, v62
    v_cvt_pk_bf16_f32 v63, v202, v203
    s_nop 0
    v_lshlrev_b32 v58, 16, v63
    v_and_b32 v59, 0xffff0000, v63
    v_mul_f32 v60, s74, v56
    v_mul_f32 v61, s74, v57
    v_exp_f32 v60, v60
    v_exp_f32 v61, v61
    s_nop 0
    v_add_f32 v60, 1.0, v60
    v_add_f32 v61, 1.0, v61
    v_rcp_f32 v60, v60
    v_rcp_f32 v61, v61
    s_nop 0
    v_mul_f32 v60, v56, v60
    v_mul_f32 v61, v57, v61
    v_cvt_pk_bf16_f32 v62, v60, v61
    s_nop 0
    v_lshlrev_b32 v60, 16, v62
    v_and_b32 v61, 0xffff0000, v62
    v_mul_f32 v60, v60, v58
    v_mul_f32 v61, v61, v59
    v_cvt_pk_bf16_f32 v53, v60, v61
    v_cvt_pk_bf16_f32 v74, v184, v185
    s_nop 0
    v_lshlrev_b32 v68, 16, v74
    v_and_b32 v69, 0xffff0000, v74
    v_cvt_pk_bf16_f32 v75, v204, v205
    s_nop 0
    v_lshlrev_b32 v70, 16, v75
    v_and_b32 v71, 0xffff0000, v75
    v_mul_f32 v72, s74, v68
    v_mul_f32 v73, s74, v69
    v_exp_f32 v72, v72
    v_exp_f32 v73, v73
    s_nop 0
    v_add_f32 v72, 1.0, v72
    v_add_f32 v73, 1.0, v73
    v_rcp_f32 v72, v72
    v_rcp_f32 v73, v73
    s_nop 0
    v_mul_f32 v72, v68, v72
    v_mul_f32 v73, v69, v73
    v_cvt_pk_bf16_f32 v74, v72, v73
    s_nop 0
    v_lshlrev_b32 v72, 16, v74
    v_and_b32 v73, 0xffff0000, v74
    v_mul_f32 v72, v72, v70
    v_mul_f32 v73, v73, v71
    v_cvt_pk_bf16_f32 v54, v72, v73
    v_cvt_pk_bf16_f32 v74, v186, v187
    s_nop 0
    v_lshlrev_b32 v68, 16, v74
    v_and_b32 v69, 0xffff0000, v74
    v_cvt_pk_bf16_f32 v75, v206, v207
    s_nop 0
    v_lshlrev_b32 v70, 16, v75
    v_and_b32 v71, 0xffff0000, v75
    v_mul_f32 v72, s74, v68
    v_mul_f32 v73, s74, v69
    v_exp_f32 v72, v72
    v_exp_f32 v73, v73
    s_nop 0
    v_add_f32 v72, 1.0, v72
    v_add_f32 v73, 1.0, v73
    v_rcp_f32 v72, v72
    v_rcp_f32 v73, v73
    s_nop 0
    v_mul_f32 v72, v68, v72
    v_mul_f32 v73, v69, v73
    v_cvt_pk_bf16_f32 v74, v72, v73
    s_nop 0
    v_lshlrev_b32 v72, 16, v74
    v_and_b32 v73, 0xffff0000, v74
    v_mul_f32 v72, v72, v70
    v_mul_f32 v73, v73, v71
    v_cvt_pk_bf16_f32 v55, v72, v73
    s_add_u32 s47, s46, 229376
    s_nop 1
    v_permlane16_swap_b32 v52, v54
    v_permlane16_swap_b32 v53, v55
    s_nop 0
    buffer_store_dwordx4 v[52:55], v15, s[16:19], s47 offen
    v_cvt_pk_bf16_f32 v62, v188, v189
    s_nop 0
    v_lshlrev_b32 v56, 16, v62
    v_and_b32 v57, 0xffff0000, v62
    v_cvt_pk_bf16_f32 v63, v208, v209
    s_nop 0
    v_lshlrev_b32 v58, 16, v63
    v_and_b32 v59, 0xffff0000, v63
    v_mul_f32 v60, s74, v56
    v_mul_f32 v61, s74, v57
    v_exp_f32 v60, v60
    v_exp_f32 v61, v61
    s_nop 0
    v_add_f32 v60, 1.0, v60
    v_add_f32 v61, 1.0, v61
    v_rcp_f32 v60, v60
    v_rcp_f32 v61, v61
    s_nop 0
    v_mul_f32 v60, v56, v60
    v_mul_f32 v61, v57, v61
    v_cvt_pk_bf16_f32 v62, v60, v61
    s_nop 0
    v_lshlrev_b32 v60, 16, v62
    v_and_b32 v61, 0xffff0000, v62
    v_mul_f32 v60, v60, v58
    v_mul_f32 v61, v61, v59
    v_cvt_pk_bf16_f32 v40, v60, v61
    v_cvt_pk_bf16_f32 v62, v190, v191
    s_nop 0
    v_lshlrev_b32 v56, 16, v62
    v_and_b32 v57, 0xffff0000, v62
    v_cvt_pk_bf16_f32 v63, v210, v211
    s_nop 0
    v_lshlrev_b32 v58, 16, v63
    v_and_b32 v59, 0xffff0000, v63
    v_mul_f32 v60, s74, v56
    v_mul_f32 v61, s74, v57
    v_exp_f32 v60, v60
    v_exp_f32 v61, v61
    s_nop 0
    v_add_f32 v60, 1.0, v60
    v_add_f32 v61, 1.0, v61
    v_rcp_f32 v60, v60
    v_rcp_f32 v61, v61
    s_nop 0
    v_mul_f32 v60, v56, v60
    v_mul_f32 v61, v57, v61
    v_cvt_pk_bf16_f32 v62, v60, v61
    s_nop 0
    v_lshlrev_b32 v60, 16, v62
    v_and_b32 v61, 0xffff0000, v62
    v_mul_f32 v60, v60, v58
    v_mul_f32 v61, v61, v59
    v_cvt_pk_bf16_f32 v41, v60, v61
    v_cvt_pk_bf16_f32 v74, v192, v193
    s_nop 0
    v_lshlrev_b32 v68, 16, v74
    v_and_b32 v69, 0xffff0000, v74
    v_cvt_pk_bf16_f32 v75, v212, v213
    s_nop 0
    v_lshlrev_b32 v70, 16, v75
    v_and_b32 v71, 0xffff0000, v75
    v_mul_f32 v72, s74, v68
    v_mul_f32 v73, s74, v69
    v_exp_f32 v72, v72
    v_exp_f32 v73, v73
    s_nop 0
    v_add_f32 v72, 1.0, v72
    v_add_f32 v73, 1.0, v73
    v_rcp_f32 v72, v72
    v_rcp_f32 v73, v73
    s_nop 0
    v_mul_f32 v72, v68, v72
    v_mul_f32 v73, v69, v73
    v_cvt_pk_bf16_f32 v74, v72, v73
    s_nop 0
    v_lshlrev_b32 v72, 16, v74
    v_and_b32 v73, 0xffff0000, v74
    v_mul_f32 v72, v72, v70
    v_mul_f32 v73, v73, v71
    v_cvt_pk_bf16_f32 v42, v72, v73
    v_cvt_pk_bf16_f32 v74, v194, v195
    s_nop 0
    v_lshlrev_b32 v68, 16, v74
    v_and_b32 v69, 0xffff0000, v74
    v_cvt_pk_bf16_f32 v75, v214, v215
    s_nop 0
    v_lshlrev_b32 v70, 16, v75
    v_and_b32 v71, 0xffff0000, v75
    v_mul_f32 v72, s74, v68
    v_mul_f32 v73, s74, v69
    v_exp_f32 v72, v72
    v_exp_f32 v73, v73
    s_nop 0
    v_add_f32 v72, 1.0, v72
    v_add_f32 v73, 1.0, v73
    v_rcp_f32 v72, v72
    v_rcp_f32 v73, v73
    s_nop 0
    v_mul_f32 v72, v68, v72
    v_mul_f32 v73, v69, v73
    v_cvt_pk_bf16_f32 v74, v72, v73
    s_nop 0
    v_lshlrev_b32 v72, 16, v74
    v_and_b32 v73, 0xffff0000, v74
    v_mul_f32 v72, v72, v70
    v_mul_f32 v73, v73, v71
    v_cvt_pk_bf16_f32 v43, v72, v73
    s_add_u32 s47, s46, 229440
    s_nop 1
    v_permlane16_swap_b32 v40, v42
    v_permlane16_swap_b32 v41, v43
    s_nop 0
    buffer_store_dwordx4 v[40:43], v15, s[16:19], s47 offen
    v_cvt_pk_bf16_f32 v62, v220, v221
    s_nop 0
    v_lshlrev_b32 v56, 16, v62
    v_and_b32 v57, 0xffff0000, v62
    v_cvt_pk_bf16_f32 v63, v240, v241
    s_nop 0
    v_lshlrev_b32 v58, 16, v63
    v_and_b32 v59, 0xffff0000, v63
    v_mul_f32 v60, s74, v56
    v_mul_f32 v61, s74, v57
    v_exp_f32 v60, v60
    v_exp_f32 v61, v61
    s_nop 0
    v_add_f32 v60, 1.0, v60
    v_add_f32 v61, 1.0, v61
    v_rcp_f32 v60, v60
    v_rcp_f32 v61, v61
    s_nop 0
    v_mul_f32 v60, v56, v60
    v_mul_f32 v61, v57, v61
    v_cvt_pk_bf16_f32 v62, v60, v61
    s_nop 0
    v_lshlrev_b32 v60, 16, v62
    v_and_b32 v61, 0xffff0000, v62
    v_mul_f32 v60, v60, v58
    v_mul_f32 v61, v61, v59
    v_cvt_pk_bf16_f32 v44, v60, v61
    v_cvt_pk_bf16_f32 v62, v222, v223
    s_nop 0
    v_lshlrev_b32 v56, 16, v62
    v_and_b32 v57, 0xffff0000, v62
    v_cvt_pk_bf16_f32 v63, v242, v243
    s_nop 0
    v_lshlrev_b32 v58, 16, v63
    v_and_b32 v59, 0xffff0000, v63
    v_mul_f32 v60, s74, v56
    v_mul_f32 v61, s74, v57
    v_exp_f32 v60, v60
    v_exp_f32 v61, v61
    s_nop 0
    v_add_f32 v60, 1.0, v60
    v_add_f32 v61, 1.0, v61
    v_rcp_f32 v60, v60
    v_rcp_f32 v61, v61
    s_nop 0
    v_mul_f32 v60, v56, v60
    v_mul_f32 v61, v57, v61
    v_cvt_pk_bf16_f32 v62, v60, v61
    s_nop 0
    v_lshlrev_b32 v60, 16, v62
    v_and_b32 v61, 0xffff0000, v62
    v_mul_f32 v60, v60, v58
    v_mul_f32 v61, v61, v59
    v_cvt_pk_bf16_f32 v45, v60, v61
    v_cvt_pk_bf16_f32 v74, v224, v225
    s_nop 0
    v_lshlrev_b32 v68, 16, v74
    v_and_b32 v69, 0xffff0000, v74
    v_cvt_pk_bf16_f32 v75, v244, v245
    s_nop 0
    v_lshlrev_b32 v70, 16, v75
    v_and_b32 v71, 0xffff0000, v75
    v_mul_f32 v72, s74, v68
    v_mul_f32 v73, s74, v69
    v_exp_f32 v72, v72
    v_exp_f32 v73, v73
    s_nop 0
    v_add_f32 v72, 1.0, v72
    v_add_f32 v73, 1.0, v73
    v_rcp_f32 v72, v72
    v_rcp_f32 v73, v73
    s_nop 0
    v_mul_f32 v72, v68, v72
    v_mul_f32 v73, v69, v73
    v_cvt_pk_bf16_f32 v74, v72, v73
    s_nop 0
    v_lshlrev_b32 v72, 16, v74
    v_and_b32 v73, 0xffff0000, v74
    v_mul_f32 v72, v72, v70
    v_mul_f32 v73, v73, v71
    v_cvt_pk_bf16_f32 v46, v72, v73
    v_cvt_pk_bf16_f32 v74, v226, v227
    s_nop 0
    v_lshlrev_b32 v68, 16, v74
    v_and_b32 v69, 0xffff0000, v74
    v_cvt_pk_bf16_f32 v75, v246, v247
    s_nop 0
    v_lshlrev_b32 v70, 16, v75
    v_and_b32 v71, 0xffff0000, v75
    v_mul_f32 v72, s74, v68
    v_mul_f32 v73, s74, v69
    v_exp_f32 v72, v72
    v_exp_f32 v73, v73
    s_nop 0
    v_add_f32 v72, 1.0, v72
    v_add_f32 v73, 1.0, v73
    v_rcp_f32 v72, v72
    v_rcp_f32 v73, v73
    s_nop 0
    v_mul_f32 v72, v68, v72
    v_mul_f32 v73, v69, v73
    v_cvt_pk_bf16_f32 v74, v72, v73
    s_nop 0
    v_lshlrev_b32 v72, 16, v74
    v_and_b32 v73, 0xffff0000, v74
    v_mul_f32 v72, v72, v70
    v_mul_f32 v73, v73, v71
    v_cvt_pk_bf16_f32 v47, v72, v73
    s_add_u32 s47, s46, 344064
    s_nop 1
    v_permlane16_swap_b32 v44, v46
    v_permlane16_swap_b32 v45, v47
    s_nop 0
    buffer_store_dwordx4 v[44:47], v15, s[16:19], s47 offen
    v_cvt_pk_bf16_f32 v62, v228, v229
    s_nop 0
    v_lshlrev_b32 v56, 16, v62
    v_and_b32 v57, 0xffff0000, v62
    v_cvt_pk_bf16_f32 v63, v248, v249
    s_nop 0
    v_lshlrev_b32 v58, 16, v63
    v_and_b32 v59, 0xffff0000, v63
    v_mul_f32 v60, s74, v56
    v_mul_f32 v61, s74, v57
    v_exp_f32 v60, v60
    v_exp_f32 v61, v61
    s_nop 0
    v_add_f32 v60, 1.0, v60
    v_add_f32 v61, 1.0, v61
    v_rcp_f32 v60, v60
    v_rcp_f32 v61, v61
    s_nop 0
    v_mul_f32 v60, v56, v60
    v_mul_f32 v61, v57, v61
    v_cvt_pk_bf16_f32 v62, v60, v61
    s_nop 0
    v_lshlrev_b32 v60, 16, v62
    v_and_b32 v61, 0xffff0000, v62
    v_mul_f32 v60, v60, v58
    v_mul_f32 v61, v61, v59
    v_cvt_pk_bf16_f32 v48, v60, v61
    v_cvt_pk_bf16_f32 v62, v230, v231
    s_nop 0
    v_lshlrev_b32 v56, 16, v62
    v_and_b32 v57, 0xffff0000, v62
    v_cvt_pk_bf16_f32 v63, v250, v251
    s_nop 0
    v_lshlrev_b32 v58, 16, v63
    v_and_b32 v59, 0xffff0000, v63
    v_mul_f32 v60, s74, v56
    v_mul_f32 v61, s74, v57
    v_exp_f32 v60, v60
    v_exp_f32 v61, v61
    s_nop 0
    v_add_f32 v60, 1.0, v60
    v_add_f32 v61, 1.0, v61
    v_rcp_f32 v60, v60
    v_rcp_f32 v61, v61
    s_nop 0
    v_mul_f32 v60, v56, v60
    v_mul_f32 v61, v57, v61
    v_cvt_pk_bf16_f32 v62, v60, v61
    s_nop 0
    v_lshlrev_b32 v60, 16, v62
    v_and_b32 v61, 0xffff0000, v62
    v_mul_f32 v60, v60, v58
    v_mul_f32 v61, v61, v59
    v_cvt_pk_bf16_f32 v49, v60, v61
    v_cvt_pk_bf16_f32 v74, v232, v233
    s_nop 0
    v_lshlrev_b32 v68, 16, v74
    v_and_b32 v69, 0xffff0000, v74
    v_cvt_pk_bf16_f32 v75, v252, v253
    s_nop 0
    v_lshlrev_b32 v70, 16, v75
    v_and_b32 v71, 0xffff0000, v75
    v_mul_f32 v72, s74, v68
    v_mul_f32 v73, s74, v69
    v_exp_f32 v72, v72
    v_exp_f32 v73, v73
    s_nop 0
    v_add_f32 v72, 1.0, v72
    v_add_f32 v73, 1.0, v73
    v_rcp_f32 v72, v72
    v_rcp_f32 v73, v73
    s_nop 0
    v_mul_f32 v72, v68, v72
    v_mul_f32 v73, v69, v73
    v_cvt_pk_bf16_f32 v74, v72, v73
    s_nop 0
    v_lshlrev_b32 v72, 16, v74
    v_and_b32 v73, 0xffff0000, v74
    v_mul_f32 v72, v72, v70
    v_mul_f32 v73, v73, v71
    v_cvt_pk_bf16_f32 v50, v72, v73
    v_cvt_pk_bf16_f32 v74, v234, v235
    s_nop 0
    v_lshlrev_b32 v68, 16, v74
    v_and_b32 v69, 0xffff0000, v74
    v_cvt_pk_bf16_f32 v75, v254, v255
    s_nop 0
    v_lshlrev_b32 v70, 16, v75
    v_and_b32 v71, 0xffff0000, v75
    v_mul_f32 v72, s74, v68
    v_mul_f32 v73, s74, v69
    v_exp_f32 v72, v72
    v_exp_f32 v73, v73
    s_nop 0
    v_add_f32 v72, 1.0, v72
    v_add_f32 v73, 1.0, v73
    v_rcp_f32 v72, v72
    v_rcp_f32 v73, v73
    s_nop 0
    v_mul_f32 v72, v68, v72
    v_mul_f32 v73, v69, v73
    v_cvt_pk_bf16_f32 v74, v72, v73
    s_nop 0
    v_lshlrev_b32 v72, 16, v74
    v_and_b32 v73, 0xffff0000, v74
    v_mul_f32 v72, v72, v70
    v_mul_f32 v73, v73, v71
    v_cvt_pk_bf16_f32 v51, v72, v73
    s_add_u32 s47, s46, 344128
    s_nop 1
    v_permlane16_swap_b32 v48, v50
    v_permlane16_swap_b32 v49, v51
    s_nop 0
    buffer_store_dwordx4 v[48:51], v15, s[16:19], s47 offen
g1_done:
    s_endpgm
.globl attn_kernel
.p2align 8
.type attn_kernel,@function
attn_kernel:
    s_cmp_ge_u32 s2, 1024
    s_cbranch_scc1 attn_done
    s_load_dwordx2 s[6:7], s[0:1], 72
    s_waitcnt lgkmcnt(0)
    s_add_u32 s8, s6, 0x400000
    s_addc_u32 s9, s7, 0
    s_mov_b32 s10, 0xc00000
    s_mov_b32 s11, 0x00020000
    s_add_u32 s12, s6, 0x2000000
    s_addc_u32 s13, s7, 0
    s_mov_b32 s14, 0x400000
    s_mov_b32 s15, 0x00020000
    v_lshrrev_b32 v1, 6, v0
    v_and_b32 v2, 63, v0
    s_nop 1
    v_readfirstlane_b32 s16, v1
    s_nop 3
    s_and_b32 s18, s2, 7
    s_lshl_b32 s18, s18, 7
    s_lshr_b32 s19, s2, 3
    s_add_u32 s18, s18, s19
    s_lshr_b32 s17, s16, 1
    s_lshl_b32 s18, s18, 1
    s_add_u32 s17, s17, s18
    s_and_b32 s18, s16, 1
    s_lshl_b32 s18, s18, 10
    v_lshlrev_b32 v3, 4, v2
    v_add_u32 v3, s18, v3
    s_mul_i32 s19, s17, 6144
    buffer_load_dwordx4 v[4:7], v3, s[8:11], s19 offen
    s_sub_i32 s20, s17, 0
    s_max_i32 s20, s20, 0
    s_mul_i32 s20, s20, 6144
    s_add_u32 s21, s20, 2048
    buffer_load_dwordx4 v[8:11], v3, s[8:11], s21 offen
    s_add_u32 s21, s20, 4096
    buffer_load_dwordx4 v[40:43], v3, s[8:11], s21 offen
    s_sub_i32 s20, s17, 2
    s_max_i32 s20, s20, 0
    s_mul_i32 s20, s20, 6144
    s_add_u32 s21, s20, 2048
    buffer_load_dwordx4 v[12:15], v3, s[8:11], s21 offen
    s_add_u32 s21, s20, 4096
    buffer_load_dwordx4 v[44:47], v3, s[8:11], s21 offen
    s_sub_i32 s20, s17, 4
    s_max_i32 s20, s20, 0
    s_mul_i32 s20, s20, 6144
    s_add_u32 s21, s20, 2048
    buffer_load_dwordx4 v[16:19], v3, s[8:11], s21 offen
    s_add_u32 s21, s20, 4096
    buffer_load_dwordx4 v[48:51], v3, s[8:11], s21 offen
    s_sub_i32 s20, s17, 6
    s_max_i32 s20, s20, 0
    s_mul_i32 s20, s20, 6144
    s_add_u32 s21, s20, 2048
    buffer_load_dwordx4 v[20:23], v3, s[8:11], s21 offen
    s_add_u32 s21, s20, 4096
    buffer_load_dwordx4 v[52:55], v3, s[8:11], s21 offen
    s_sub_i32 s20, s17, 8
    s_max_i32 s20, s20, 0
    s_mul_i32 s20, s20, 6144
    s_add_u32 s21, s20, 2048
    buffer_load_dwordx4 v[24:27], v3, s[8:11], s21 offen
    s_add_u32 s21, s20, 4096
    buffer_load_dwordx4 v[56:59], v3, s[8:11], s21 offen
    s_sub_i32 s20, s17, 10
    s_max_i32 s20, s20, 0
    s_mul_i32 s20, s20, 6144
    s_add_u32 s21, s20, 2048
    buffer_load_dwordx4 v[28:31], v3, s[8:11], s21 offen
    s_add_u32 s21, s20, 4096
    buffer_load_dwordx4 v[60:63], v3, s[8:11], s21 offen
    s_sub_i32 s20, s17, 12
    s_max_i32 s20, s20, 0
    s_mul_i32 s20, s20, 6144
    s_add_u32 s21, s20, 2048
    buffer_load_dwordx4 v[32:35], v3, s[8:11], s21 offen
    s_add_u32 s21, s20, 4096
    buffer_load_dwordx4 v[64:67], v3, s[8:11], s21 offen
    s_sub_i32 s20, s17, 14
    s_max_i32 s20, s20, 0
    s_mul_i32 s20, s20, 6144
    s_add_u32 s21, s20, 2048
    buffer_load_dwordx4 v[36:39], v3, s[8:11], s21 offen
    s_add_u32 s21, s20, 4096
    buffer_load_dwordx4 v[68:71], v3, s[8:11], s21 offen
    s_mov_b32 s24, 0x3e3504f3
    v_mov_b32 v90, 0xce6e6b28
    v_cvt_pk_bf16_f32 v90, v90, v90
    s_nop 0
    v_and_b32 v90, 0xffff0000, v90
    s_waitcnt vmcnt(15)
    v_mov_b32 v80, 0
    v_dot2_f32_bf16 v80, v4, v8, v80
    v_dot2_f32_bf16 v80, v5, v9, v80
    v_dot2_f32_bf16 v80, v6, v10, v80
    v_dot2_f32_bf16 v80, v7, v11, v80
    s_nop 2
    v_add_f32_dpp v81, v80, v80 quad_perm:[1,0,3,2] row_mask:0xf bank_mask:0xf
    s_nop 1
    v_add_f32_dpp v80, v81, v81 quad_perm:[2,3,0,1] row_mask:0xf bank_mask:0xf
    v_cvt_pk_bf16_f32 v81, v80, v80
    s_nop 0
    v_and_b32 v81, 0xffff0000, v81
    v_mul_f32 v81, s24, v81
    v_cvt_pk_bf16_f32 v81, v81, v81
    s_nop 0
    v_and_b32 v72, 0xffff0000, v81
    s_waitcnt vmcnt(13)
    v_mov_b32 v80, 0
    v_dot2_f32_bf16 v80, v4, v12, v80
    v_dot2_f32_bf16 v80, v5, v13, v80
    v_dot2_f32_bf16 v80, v6, v14, v80
    v_dot2_f32_bf16 v80, v7, v15, v80
    s_nop 2
    v_add_f32_dpp v81, v80, v80 quad_perm:[1,0,3,2] row_mask:0xf bank_mask:0xf
    s_nop 1
    v_add_f32_dpp v80, v81, v81 quad_perm:[2,3,0,1] row_mask:0xf bank_mask:0xf
    v_cvt_pk_bf16_f32 v81, v80, v80
    s_nop 0
    v_and_b32 v81, 0xffff0000, v81
    v_mul_f32 v81, s24, v81
    v_cvt_pk_bf16_f32 v81, v81, v81
    s_nop 0
    v_and_b32 v73, 0xffff0000, v81
    s_cmp_lt_u32 s17, 2
    s_cselect_b64 s[26:27], -1, 0
    s_nop 1
    v_cndmask_b32 v73, v73, v90, s[26:27]
    s_waitcnt vmcnt(11)
    v_mov_b32 v80, 0
    v_dot2_f32_bf16 v80, v4, v16, v80
    v_dot2_f32_bf16 v80, v5, v17, v80
    v_dot2_f32_bf16 v80, v6, v18, v80
    v_dot2_f32_bf16 v80, v7, v19, v80
    s_nop 2
    v_add_f32_dpp v81, v80, v80 quad_perm:[1,0,3,2] row_mask:0xf bank_mask:0xf
    s_nop 1
    v_add_f32_dpp v80, v81, v81 quad_perm:[2,3,0,1] row_mask:0xf bank_mask:0xf
    v_cvt_pk_bf16_f32 v81, v80, v80
    s_nop 0
    v_and_b32 v81, 0xffff0000, v81
    v_mul_f32 v81, s24, v81
    v_cvt_pk_bf16_f32 v81, v81, v81
    s_nop 0
    v_and_b32 v74, 0xffff0000, v81
    s_cmp_lt_u32 s17, 4
    s_cselect_b64 s[26:27], -1, 0
    s_nop 1
    v_cndmask_b32 v74, v74, v90, s[26:27]
    s_waitcnt vmcnt(9)
    v_mov_b32 v80, 0
    v_dot2_f32_bf16 v80, v4, v20, v80
    v_dot2_f32_bf16 v80, v5, v21, v80
    v_dot2_f32_bf16 v80, v6, v22, v80
    v_dot2_f32_bf16 v80, v7, v23, v80
    s_nop 2
    v_add_f32_dpp v81, v80, v80 quad_perm:[1,0,3,2] row_mask:0xf bank_mask:0xf
    s_nop 1
    v_add_f32_dpp v80, v81, v81 quad_perm:[2,3,0,1] row_mask:0xf bank_mask:0xf
    v_cvt_pk_bf16_f32 v81, v80, v80
    s_nop 0
    v_and_b32 v81, 0xffff0000, v81
    v_mul_f32 v81, s24, v81
    v_cvt_pk_bf16_f32 v81, v81, v81
    s_nop 0
    v_and_b32 v75, 0xffff0000, v81
    s_cmp_lt_u32 s17, 6
    s_cselect_b64 s[26:27], -1, 0
    s_nop 1
    v_cndmask_b32 v75, v75, v90, s[26:27]
    s_waitcnt vmcnt(7)
    v_mov_b32 v80, 0
    v_dot2_f32_bf16 v80, v4, v24, v80
    v_dot2_f32_bf16 v80, v5, v25, v80
    v_dot2_f32_bf16 v80, v6, v26, v80
    v_dot2_f32_bf16 v80, v7, v27, v80
    s_nop 2
    v_add_f32_dpp v81, v80, v80 quad_perm:[1,0,3,2] row_mask:0xf bank_mask:0xf
    s_nop 1
    v_add_f32_dpp v80, v81, v81 quad_perm:[2,3,0,1] row_mask:0xf bank_mask:0xf
    v_cvt_pk_bf16_f32 v81, v80, v80
    s_nop 0
    v_and_b32 v81, 0xffff0000, v81
    v_mul_f32 v81, s24, v81
    v_cvt_pk_bf16_f32 v81, v81, v81
    s_nop 0
    v_and_b32 v76, 0xffff0000, v81
    s_cmp_lt_u32 s17, 8
    s_cselect_b64 s[26:27], -1, 0
    s_nop 1
    v_cndmask_b32 v76, v76, v90, s[26:27]
    s_waitcnt vmcnt(5)
    v_mov_b32 v80, 0
    v_dot2_f32_bf16 v80, v4, v28, v80
    v_dot2_f32_bf16 v80, v5, v29, v80
    v_dot2_f32_bf16 v80, v6, v30, v80
    v_dot2_f32_bf16 v80, v7, v31, v80
    s_nop 2
    v_add_f32_dpp v81, v80, v80 quad_perm:[1,0,3,2] row_mask:0xf bank_mask:0xf
    s_nop 1
    v_add_f32_dpp v80, v81, v81 quad_perm:[2,3,0,1] row_mask:0xf bank_mask:0xf
    v_cvt_pk_bf16_f32 v81, v80, v80
    s_nop 0
    v_and_b32 v81, 0xffff0000, v81
    v_mul_f32 v81, s24, v81
    v_cvt_pk_bf16_f32 v81, v81, v81
    s_nop 0
    v_and_b32 v77, 0xffff0000, v81
    s_cmp_lt_u32 s17, 10
    s_cselect_b64 s[26:27], -1, 0
    s_nop 1
    v_cndmask_b32 v77, v77, v90, s[26:27]
    s_waitcnt vmcnt(3)
    v_mov_b32 v80, 0
    v_dot2_f32_bf16 v80, v4, v32, v80
    v_dot2_f32_bf16 v80, v5, v33, v80
    v_dot2_f32_bf16 v80, v6, v34, v80
    v_dot2_f32_bf16 v80, v7, v35, v80
    s_nop 2
    v_add_f32_dpp v81, v80, v80 quad_perm:[1,0,3,2] row_mask:0xf bank_mask:0xf
    s_nop 1
    v_add_f32_dpp v80, v81, v81 quad_perm:[2,3,0,1] row_mask:0xf bank_mask:0xf
    v_cvt_pk_bf16_f32 v81, v80, v80
    s_nop 0
    v_and_b32 v81, 0xffff0000, v81
    v_mul_f32 v81, s24, v81
    v_cvt_pk_bf16_f32 v81, v81, v81
    s_nop 0
    v_and_b32 v78, 0xffff0000, v81
    s_cmp_lt_u32 s17, 12
    s_cselect_b64 s[26:27], -1, 0
    s_nop 1
    v_cndmask_b32 v78, v78, v90, s[26:27]
    s_waitcnt vmcnt(1)
    v_mov_b32 v80, 0
    v_dot2_f32_bf16 v80, v4, v36, v80
    v_dot2_f32_bf16 v80, v5, v37, v80
    v_dot2_f32_bf16 v80, v6, v38, v80
    v_dot2_f32_bf16 v80, v7, v39, v80
    s_nop 2
    v_add_f32_dpp v81, v80, v80 quad_perm:[1,0,3,2] row_mask:0xf bank_mask:0xf
    s_nop 1
    v_add_f32_dpp v80, v81, v81 quad_perm:[2,3,0,1] row_mask:0xf bank_mask:0xf
    v_cvt_pk_bf16_f32 v81, v80, v80
    s_nop 0
    v_and_b32 v81, 0xffff0000, v81
    v_mul_f32 v81, s24, v81
    v_cvt_pk_bf16_f32 v81, v81, v81
    s_nop 0
    v_and_b32 v79, 0xffff0000, v81
    s_cmp_lt_u32 s17, 14
    s_cselect_b64 s[26:27], -1, 0
    s_nop 1
    v_cndmask_b32 v79, v79, v90, s[26:27]
    v_max3_f32 v82, v72, v73, v74
    v_max3_f32 v82, v82, v75, v76
    v_max3_f32 v82, v82, v77, v78
    v_max_f32 v82, v82, v79
    s_mov_b32 s25, 0x3fb8aa3b
    v_sub_f32 v72, v72, v82
    v_mul_f32 v72, s25, v72
    v_sub_f32 v73, v73, v82
    v_mul_f32 v73, s25, v73
    v_sub_f32 v74, v74, v82
    v_mul_f32 v74, s25, v74
    v_sub_f32 v75, v75, v82
    v_mul_f32 v75, s25, v75
    v_sub_f32 v76, v76, v82
    v_mul_f32 v76, s25, v76
    v_sub_f32 v77, v77, v82
    v_mul_f32 v77, s25, v77
    v_sub_f32 v78, v78, v82
    v_mul_f32 v78, s25, v78
    v_sub_f32 v79, v79, v82
    v_mul_f32 v79, s25, v79
    v_exp_f32 v72, v72
    v_exp_f32 v73, v73
    v_exp_f32 v74, v74
    v_exp_f32 v75, v75
    v_exp_f32 v76, v76
    v_exp_f32 v77, v77
    v_exp_f32 v78, v78
    v_exp_f32 v79, v79
    s_nop 0
    v_add_f32 v83, v72, v73
    v_add_f32 v83, v83, v74
    v_add_f32 v83, v83, v75
    v_add_f32 v83, v83, v76
    v_add_f32 v83, v83, v77
    v_add_f32 v83, v83, v78
    v_add_f32 v83, v83, v79
    v_rcp_f32 v83, v83
    s_nop 0
    v_mul_f32 v72, v72, v83
    v_mul_f32 v73, v73, v83
    v_mul_f32 v74, v74, v83
    v_mul_f32 v75, v75, v83
    v_mul_f32 v76, v76, v83
    v_mul_f32 v77, v77, v83
    v_mul_f32 v78, v78, v83
    v_mul_f32 v79, v79, v83
    v_cvt_pk_bf16_f32 v84, v72, v73
    s_nop 0
    v_lshlrev_b32 v72, 16, v84
    v_and_b32 v73, 0xffff0000, v84
    v_cvt_pk_bf16_f32 v84, v74, v75
    s_nop 0
    v_lshlrev_b32 v74, 16, v84
    v_and_b32 v75, 0xffff0000, v84
    v_cvt_pk_bf16_f32 v84, v76, v77
    s_nop 0
    v_lshlrev_b32 v76, 16, v84
    v_and_b32 v77, 0xffff0000, v84
    v_cvt_pk_bf16_f32 v84, v78, v79
    s_nop 0
    v_lshlrev_b32 v78, 16, v84
    v_and_b32 v79, 0xffff0000, v84
    s_waitcnt vmcnt(0)
    v_mov_b32 v92, 0
    v_mov_b32 v93, 0
    v_mov_b32 v94, 0
    v_mov_b32 v95, 0
    v_mov_b32 v96, 0
    v_mov_b32 v97, 0
    v_mov_b32 v98, 0
    v_mov_b32 v99, 0
    v_lshlrev_b32 v84, 16, v40
    v_and_b32 v85, 0xffff0000, v40
    v_fmac_f32 v92, v72, v84
    v_fmac_f32 v93, v72, v85
    v_lshlrev_b32 v84, 16, v41
    v_and_b32 v85, 0xffff0000, v41
    v_fmac_f32 v94, v72, v84
    v_fmac_f32 v95, v72, v85
    v_lshlrev_b32 v84, 16, v42
    v_and_b32 v85, 0xffff0000, v42
    v_fmac_f32 v96, v72, v84
    v_fmac_f32 v97, v72, v85
    v_lshlrev_b32 v84, 16, v43
    v_and_b32 v85, 0xffff0000, v43
    v_fmac_f32 v98, v72, v84
    v_fmac_f32 v99, v72, v85
    v_lshlrev_b32 v84, 16, v44
    v_and_b32 v85, 0xffff0000, v44
    v_fmac_f32 v92, v73, v84
    v_fmac_f32 v93, v73, v85
    v_lshlrev_b32 v84, 16, v45
    v_and_b32 v85, 0xffff0000, v45
    v_fmac_f32 v94, v73, v84
    v_fmac_f32 v95, v73, v85
    v_lshlrev_b32 v84, 16, v46
    v_and_b32 v85, 0xffff0000, v46
    v_fmac_f32 v96, v73, v84
    v_fmac_f32 v97, v73, v85
    v_lshlrev_b32 v84, 16, v47
    v_and_b32 v85, 0xffff0000, v47
    v_fmac_f32 v98, v73, v84
    v_fmac_f32 v99, v73, v85
    v_lshlrev_b32 v84, 16, v48
    v_and_b32 v85, 0xffff0000, v48
    v_fmac_f32 v92, v74, v84
    v_fmac_f32 v93, v74, v85
    v_lshlrev_b32 v84, 16, v49
    v_and_b32 v85, 0xffff0000, v49
    v_fmac_f32 v94, v74, v84
    v_fmac_f32 v95, v74, v85
    v_lshlrev_b32 v84, 16, v50
    v_and_b32 v85, 0xffff0000, v50
    v_fmac_f32 v96, v74, v84
    v_fmac_f32 v97, v74, v85
    v_lshlrev_b32 v84, 16, v51
    v_and_b32 v85, 0xffff0000, v51
    v_fmac_f32 v98, v74, v84
    v_fmac_f32 v99, v74, v85
    v_lshlrev_b32 v84, 16, v52
    v_and_b32 v85, 0xffff0000, v52
    v_fmac_f32 v92, v75, v84
    v_fmac_f32 v93, v75, v85
    v_lshlrev_b32 v84, 16, v53
    v_and_b32 v85, 0xffff0000, v53
    v_fmac_f32 v94, v75, v84
    v_fmac_f32 v95, v75, v85
    v_lshlrev_b32 v84, 16, v54
    v_and_b32 v85, 0xffff0000, v54
    v_fmac_f32 v96, v75, v84
    v_fmac_f32 v97, v75, v85
    v_lshlrev_b32 v84, 16, v55
    v_and_b32 v85, 0xffff0000, v55
    v_fmac_f32 v98, v75, v84
    v_fmac_f32 v99, v75, v85
    v_lshlrev_b32 v84, 16, v56
    v_and_b32 v85, 0xffff0000, v56
    v_fmac_f32 v92, v76, v84
    v_fmac_f32 v93, v76, v85
    v_lshlrev_b32 v84, 16, v57
    v_and_b32 v85, 0xffff0000, v57
    v_fmac_f32 v94, v76, v84
    v_fmac_f32 v95, v76, v85
    v_lshlrev_b32 v84, 16, v58
    v_and_b32 v85, 0xffff0000, v58
    v_fmac_f32 v96, v76, v84
    v_fmac_f32 v97, v76, v85
    v_lshlrev_b32 v84, 16, v59
    v_and_b32 v85, 0xffff0000, v59
    v_fmac_f32 v98, v76, v84
    v_fmac_f32 v99, v76, v85
    v_lshlrev_b32 v84, 16, v60
    v_and_b32 v85, 0xffff0000, v60
    v_fmac_f32 v92, v77, v84
    v_fmac_f32 v93, v77, v85
    v_lshlrev_b32 v84, 16, v61
    v_and_b32 v85, 0xffff0000, v61
    v_fmac_f32 v94, v77, v84
    v_fmac_f32 v95, v77, v85
    v_lshlrev_b32 v84, 16, v62
    v_and_b32 v85, 0xffff0000, v62
    v_fmac_f32 v96, v77, v84
    v_fmac_f32 v97, v77, v85
    v_lshlrev_b32 v84, 16, v63
    v_and_b32 v85, 0xffff0000, v63
    v_fmac_f32 v98, v77, v84
    v_fmac_f32 v99, v77, v85
    v_lshlrev_b32 v84, 16, v64
    v_and_b32 v85, 0xffff0000, v64
    v_fmac_f32 v92, v78, v84
    v_fmac_f32 v93, v78, v85
    v_lshlrev_b32 v84, 16, v65
    v_and_b32 v85, 0xffff0000, v65
    v_fmac_f32 v94, v78, v84
    v_fmac_f32 v95, v78, v85
    v_lshlrev_b32 v84, 16, v66
    v_and_b32 v85, 0xffff0000, v66
    v_fmac_f32 v96, v78, v84
    v_fmac_f32 v97, v78, v85
    v_lshlrev_b32 v84, 16, v67
    v_and_b32 v85, 0xffff0000, v67
    v_fmac_f32 v98, v78, v84
    v_fmac_f32 v99, v78, v85
    v_lshlrev_b32 v84, 16, v68
    v_and_b32 v85, 0xffff0000, v68
    v_fmac_f32 v92, v79, v84
    v_fmac_f32 v93, v79, v85
    v_lshlrev_b32 v84, 16, v69
    v_and_b32 v85, 0xffff0000, v69
    v_fmac_f32 v94, v79, v84
    v_fmac_f32 v95, v79, v85
    v_lshlrev_b32 v84, 16, v70
    v_and_b32 v85, 0xffff0000, v70
    v_fmac_f32 v96, v79, v84
    v_fmac_f32 v97, v79, v85
    v_lshlrev_b32 v84, 16, v71
    v_and_b32 v85, 0xffff0000, v71
    v_fmac_f32 v98, v79, v84
    v_fmac_f32 v99, v79, v85
    v_cvt_pk_bf16_f32 v100, v92, v93
    v_cvt_pk_bf16_f32 v101, v94, v95
    v_cvt_pk_bf16_f32 v102, v96, v97
    v_cvt_pk_bf16_f32 v103, v98, v99
    s_lshl_b32 s19, s17, 11
    s_nop 0
    buffer_store_dwordx4 v[100:103], v3, s[12:15], s19 offen
attn_done:
    s_endpgm
.globl g2_kernel
.p2align 8
.type g2_kernel,@function
g2_kernel:
    s_cmp_ge_u32 s2, 256
    s_cbranch_scc1 g2_done
    s_load_dwordx2 s[30:31], s[0:1], 72
    s_load_dwordx2 s[32:33], s[0:1], 16
    s_load_dwordx2 s[34:35], s[0:1], 48
    s_load_dwordx2 s[36:37], s[0:1], 0
    s_load_dwordx2 s[38:39], s[0:1], 56
    s_and_b32 s40, s2, 7
    s_lshr_b32 s41, s2, 3
    s_and_b32 s28, s40, 3
    s_lshl_b32 s28, s28, 3
    s_and_b32 s42, s41, 7
    s_add_u32 s28, s28, s42
    s_lshr_b32 s29, s40, 2
    s_lshl_b32 s29, s29, 2
    s_lshr_b32 s42, s41, 3
    s_add_u32 s29, s29, s42
    v_lshrrev_b32 v1, 6, v0
    v_and_b32 v22, 63, v0
    s_nop 1
    v_readfirstlane_b32 s25, v1
    s_nop 3
    s_waitcnt lgkmcnt(0)
    s_cmp_lt_u32 s25, 4
    s_cbranch_scc1 g2_consumer
    s_sub_u32 s25, s25, 4
    s_add_u32 s4, s30, 0x2000000
    s_addc_u32 s5, s31, 0
    s_mov_b32 s6, 0x400000
    s_mov_b32 s7, 0x00020000
    s_add_u32 s48, s30, 0x1000000
    s_addc_u32 s49, s31, 0
    s_mov_b32 s50, 0xe00000
    s_mov_b32 s51, 0x00020000
    s_mov_b32 s8, s32
    s_mov_b32 s9, s33
    s_mov_b32 s10, 0x200000
    s_mov_b32 s11, 0x00020000
    s_mov_b32 s52, s34
    s_mov_b32 s53, s35
    s_mov_b32 s54, 0x700000
    s_mov_b32 s55, 0x00020000
    v_lshrrev_b32 v23, 3, v22
    v_and_b32 v24, 7, v22
    s_lshl_b32 s40, s28, 6
    s_lshl_b32 s41, s25, 4
    v_add_u32 v25, s41, v23
    v_lshrrev_b32 v26, 1, v25
    v_and_b32 v26, 7, v26
    v_xor_b32 v26, v26, v24
    v_lshlrev_b32 v26, 4, v26
    v_add_u32 v25, s40, v25
    v_lshlrev_b32 v27, 11, v25
    v_add_u32 v8, v27, v26
    v_mul_u32_u24 v27, 7168, v25
    v_add_u32 v10, v27, v26
    v_add_u32 v25, s41, v23
    v_add_u32 v25, 8, v25
    v_lshrrev_b32 v26, 1, v25
    v_and_b32 v26, 7, v26
    v_xor_b32 v26, v26, v24
    v_lshlrev_b32 v26, 4, v26
    v_add_u32 v25, s40, v25
    v_lshlrev_b32 v27, 11, v25
    v_add_u32 v9, v27, v26
    v_mul_u32_u24 v27, 7168, v25
    v_add_u32 v11, v27, v26
    v_lshrrev_b32 v23, 4, v22
    v_and_b32 v24, 15, v22
    v_add_u32 v25, s41, v23
    v_and_b32 v26, 7, v25
    v_lshrrev_b32 v27, 1, v24
    v_xor_b32 v26, v26, v27
    v_lshlrev_b32 v26, 5, v26
    v_and_b32 v27, 1, v24
    v_lshlrev_b32 v27, 4, v27
    v_add_u32 v26, v26, v27
    v_and_b32 v28, 32, v25
    v_and_b32 v29, 15, v25
    v_lshrrev_b32 v29, 2, v29
    v_lshlrev_b32 v29, 3, v29
    v_add_u32 v28, v28, v29
    v_and_b32 v29, 16, v25
    v_lshrrev_b32 v29, 2, v29
    v_add_u32 v28, v28, v29
    v_and_b32 v29, 3, v25
    v_add_u32 v28, v28, v29
    v_lshlrev_b32 v28, 11, v28
    s_lshl_b32 s42, s29, 8
    v_add_u32 v28, s42, v28
    v_add_u32 v12, v28, v26
    v_add_u32 v25, s41, v23
    v_add_u32 v25, 4, v25
    v_and_b32 v26, 7, v25
    v_lshrrev_b32 v27, 1, v24
    v_xor_b32 v26, v26, v27
    v_lshlrev_b32 v26, 5, v26
    v_and_b32 v27, 1, v24
    v_lshlrev_b32 v27, 4, v27
    v_add_u32 v26, v26, v27
    v_and_b32 v28, 32, v25
    v_and_b32 v29, 15, v25
    v_lshrrev_b32 v29, 2, v29
    v_lshlrev_b32 v29, 3, v29
    v_add_u32 v28, v28, v29
    v_and_b32 v29, 16, v25
    v_lshrrev_b32 v29, 2, v29
    v_add_u32 v28, v28, v29
    v_and_b32 v29, 3, v25
    v_add_u32 v28, v28, v29
    v_lshlrev_b32 v28, 11, v28
    s_lshl_b32 s42, s29, 8
    v_add_u32 v28, s42, v28
    v_add_u32 v13, v28, v26
    v_add_u32 v25, s41, v23
    v_add_u32 v25, 8, v25
    v_and_b32 v26, 7, v25
    v_lshrrev_b32 v27, 1, v24
    v_xor_b32 v26, v26, v27
    v_lshlrev_b32 v26, 5, v26
    v_and_b32 v27, 1, v24
    v_lshlrev_b32 v27, 4, v27
    v_add_u32 v26, v26, v27
    v_and_b32 v28, 32, v25
    v_and_b32 v29, 15, v25
    v_lshrrev_b32 v29, 2, v29
    v_lshlrev_b32 v29, 3, v29
    v_add_u32 v28, v28, v29
    v_and_b32 v29, 16, v25
    v_lshrrev_b32 v29, 2, v29
    v_add_u32 v28, v28, v29
    v_and_b32 v29, 3, v25
    v_add_u32 v28, v28, v29
    v_lshlrev_b32 v28, 11, v28
    s_lshl_b32 s42, s29, 8
    v_add_u32 v28, s42, v28
    v_add_u32 v14, v28, v26
    v_add_u32 v25, s41, v23
    v_add_u32 v25, 12, v25
    v_and_b32 v26, 7, v25
    v_lshrrev_b32 v27, 1, v24
    v_xor_b32 v26, v26, v27
    v_lshlrev_b32 v26, 5, v26
    v_and_b32 v27, 1, v24
    v_lshlrev_b32 v27, 4, v27
    v_add_u32 v26, v26, v27
    v_and_b32 v28, 32, v25
    v_and_b32 v29, 15, v25
    v_lshrrev_b32 v29, 2, v29
    v_lshlrev_b32 v29, 3, v29
    v_add_u32 v28, v28, v29
    v_and_b32 v29, 16, v25
    v_lshrrev_b32 v29, 2, v29
    v_add_u32 v28, v28, v29
    v_and_b32 v29, 3, v25
    v_add_u32 v28, v28, v29
    v_lshlrev_b32 v28, 11, v28
    s_lshl_b32 s42, s29, 8
    v_add_u32 v28, s42, v28
    v_add_u32 v15, v28, v26
    s_lshl_b32 s43, s25, 11
    s_lshl_b32 s44, s25, 12
    s_mov_b32 s20, 0
    s_mov_b32 s21, 0
    s_mov_b32 s23, 0
    s_add_u32 m0, s23, 0
    s_add_u32 m0, m0, s43
    s_nop 0
    buffer_load_dwordx4 v8, s[4:7], s20 offen lds
    s_add_u32 m0, s23, 1024
    s_add_u32 m0, m0, s43
    s_nop 0
    buffer_load_dwordx4 v9, s[4:7], s20 offen lds
    s_add_u32 m0, s23, 8192
    s_add_u32 m0, m0, s44
    s_nop 0
    buffer_load_dwordx4 v12, s[8:11], s21 offen lds
    s_add_u32 m0, s23, 9216
    s_add_u32 m0, m0, s44
    s_nop 0
    buffer_load_dwordx4 v13, s[8:11], s21 offen lds
    s_add_u32 m0, s23, 10240
    s_add_u32 m0, m0, s44
    s_nop 0
    buffer_load_dwordx4 v14, s[8:11], s21 offen lds
    s_add_u32 m0, s23, 11264
    s_add_u32 m0, m0, s44
    s_nop 0
    buffer_load_dwordx4 v15, s[8:11], s21 offen lds
    s_add_u32 s20, s20, 128
    s_add_u32 s21, s21, 131072
    s_add_u32 s23, s23, 24576
    s_cmp_ge_u32 s23, 147456
    s_cselect_b32 s23, 0, s23
    s_add_u32 m0, s23, 0
    s_add_u32 m0, m0, s43
    s_nop 0
    buffer_load_dwordx4 v8, s[4:7], s20 offen lds
    s_add_u32 m0, s23, 1024
    s_add_u32 m0, m0, s43
    s_nop 0
    buffer_load_dwordx4 v9, s[4:7], s20 offen lds
    s_add_u32 m0, s23, 8192
    s_add_u32 m0, m0, s44
    s_nop 0
    buffer_load_dwordx4 v12, s[8:11], s21 offen lds
    s_add_u32 m0, s23, 9216
    s_add_u32 m0, m0, s44
    s_nop 0
    buffer_load_dwordx4 v13, s[8:11], s21 offen lds
    s_add_u32 m0, s23, 10240
    s_add_u32 m0, m0, s44
    s_nop 0
    buffer_load_dwordx4 v14, s[8:11], s21 offen lds
    s_add_u32 m0, s23, 11264
    s_add_u32 m0, m0, s44
    s_nop 0
    buffer_load_dwordx4 v15, s[8:11], s21 offen lds
    s_add_u32 s20, s20, 128
    s_add_u32 s21, s21, 131072
    s_add_u32 s23, s23, 24576
    s_cmp_ge_u32 s23, 147456
    s_cselect_b32 s23, 0, s23
    s_add_u32 m0, s23, 0
    s_add_u32 m0, m0, s43
    s_nop 0
    buffer_load_dwordx4 v8, s[4:7], s20 offen lds
    s_add_u32 m0, s23, 1024
    s_add_u32 m0, m0, s43
    s_nop 0
    buffer_load_dwordx4 v9, s[4:7], s20 offen lds
    s_add_u32 m0, s23, 8192
    s_add_u32 m0, m0, s44
    s_nop 0
    buffer_load_dwordx4 v12, s[8:11], s21 offen lds
    s_add_u32 m0, s23, 9216
    s_add_u32 m0, m0, s44
    s_nop 0
    buffer_load_dwordx4 v13, s[8:11], s21 offen lds
    s_add_u32 m0, s23, 10240
    s_add_u32 m0, m0, s44
    s_nop 0
    buffer_load_dwordx4 v14, s[8:11], s21 offen lds
    s_add_u32 m0, s23, 11264
    s_add_u32 m0, m0, s44
    s_nop 0
    buffer_load_dwordx4 v15, s[8:11], s21 offen lds
    s_add_u32 s20, s20, 128
    s_add_u32 s21, s21, 131072
    s_add_u32 s23, s23, 24576
    s_cmp_ge_u32 s23, 147456
    s_cselect_b32 s23, 0, s23
    s_add_u32 m0, s23, 0
    s_add_u32 m0, m0, s43
    s_nop 0
    buffer_load_dwordx4 v8, s[4:7], s20 offen lds
    s_add_u32 m0, s23, 1024
    s_add_u32 m0, m0, s43
    s_nop 0
    buffer_load_dwordx4 v9, s[4:7], s20 offen lds
    s_add_u32 m0, s23, 8192
    s_add_u32 m0, m0, s44
    s_nop 0
    buffer_load_dwordx4 v12, s[8:11], s21 offen lds
    s_add_u32 m0, s23, 9216
    s_add_u32 m0, m0, s44
    s_nop 0
    buffer_load_dwordx4 v13, s[8:11], s21 offen lds
    s_add_u32 m0, s23, 10240
    s_add_u32 m0, m0, s44
    s_nop 0
    buffer_load_dwordx4 v14, s[8:11], s21 offen lds
    s_add_u32 m0, s23, 11264
    s_add_u32 m0, m0, s44
    s_nop 0
    buffer_load_dwordx4 v15, s[8:11], s21 offen lds
    s_add_u32 s20, s20, 128
    s_add_u32 s21, s21, 131072
    s_add_u32 s23, s23, 24576
    s_cmp_ge_u32 s23, 147456
    s_cselect_b32 s23, 0, s23
    s_add_u32 m0, s23, 0
    s_add_u32 m0, m0, s43
    s_nop 0
    buffer_load_dwordx4 v8, s[4:7], s20 offen lds
    s_add_u32 m0, s23, 1024
    s_add_u32 m0, m0, s43
    s_nop 0
    buffer_load_dwordx4 v9, s[4:7], s20 offen lds
    s_add_u32 m0, s23, 8192
    s_add_u32 m0, m0, s44
    s_nop 0
    buffer_load_dwordx4 v12, s[8:11], s21 offen lds
    s_add_u32 m0, s23, 9216
    s_add_u32 m0, m0, s44
    s_nop 0
    buffer_load_dwordx4 v13, s[8:11], s21 offen lds
    s_add_u32 m0, s23, 10240
    s_add_u32 m0, m0, s44
    s_nop 0
    buffer_load_dwordx4 v14, s[8:11], s21 offen lds
    s_add_u32 m0, s23, 11264
    s_add_u32 m0, m0, s44
    s_nop 0
    buffer_load_dwordx4 v15, s[8:11], s21 offen lds
    s_add_u32 s20, s20, 128
    s_add_u32 s21, s21, 131072
    s_add_u32 s23, s23, 24576
    s_cmp_ge_u32 s23, 147456
    s_cselect_b32 s23, 0, s23
    s_waitcnt vmcnt(24)
    s_barrier
    s_mov_b32 s22, 0
g2p_l1:
    s_waitcnt vmcnt(18)
    s_barrier
    s_add_u32 m0, s23, 0
    s_add_u32 m0, m0, s43
    s_nop 0
    buffer_load_dwordx4 v8, s[4:7], s20 offen lds
    s_add_u32 m0, s23, 1024
    s_add_u32 m0, m0, s43
    s_nop 0
    buffer_load_dwordx4 v9, s[4:7], s20 offen lds
    s_add_u32 m0, s23, 8192
    s_add_u32 m0, m0, s44
    s_nop 0
    buffer_load_dwordx4 v12, s[8:11], s21 offen lds
    s_add_u32 m0, s23, 9216
    s_add_u32 m0, m0, s44
    s_nop 0
    buffer_load_dwordx4 v13, s[8:11], s21 offen lds
    s_add_u32 m0, s23, 10240
    s_add_u32 m0, m0, s44
    s_nop 0
    buffer_load_dwordx4 v14, s[8:11], s21 offen lds
    s_add_u32 m0, s23, 11264
    s_add_u32 m0, m0, s44
    s_nop 0
    buffer_load_dwordx4 v15, s[8:11], s21 offen lds
    s_add_u32 s20, s20, 128
    s_add_u32 s21, s21, 131072
    s_add_u32 s23, s23, 24576
    s_cmp_ge_u32 s23, 147456
    s_cselect_b32 s23, 0, s23
    s_add_u32 s22, s22, 1
    s_cmp_lt_u32 s22, 11
    s_cbranch_scc1 g2p_l1
    s_waitcnt vmcnt(18)
    s_barrier
    v_mov_b32 v8, v10
    v_mov_b32 v9, v11
    s_mov_b32 s4, s48
    s_mov_b32 s8, s52
    s_mov_b32 s5, s49
    s_mov_b32 s9, s53
    s_mov_b32 s6, s50
    s_mov_b32 s10, s54
    s_mov_b32 s7, s51
    s_mov_b32 s11, s55
    s_mov_b32 s20, 0
    s_mov_b32 s21, 0
    s_add_u32 m0, s23, 0
    s_add_u32 m0, m0, s43
    s_nop 0
    buffer_load_dwordx4 v8, s[4:7], s20 offen lds
    s_add_u32 m0, s23, 1024
    s_add_u32 m0, m0, s43
    s_nop 0
    buffer_load_dwordx4 v9, s[4:7], s20 offen lds
    s_add_u32 m0, s23, 8192
    s_add_u32 m0, m0, s44
    s_nop 0
    buffer_load_dwordx4 v12, s[8:11], s21 offen lds
    s_add_u32 m0, s23, 9216
    s_add_u32 m0, m0, s44
    s_nop 0
    buffer_load_dwordx4 v13, s[8:11], s21 offen lds
    s_add_u32 m0, s23, 10240
    s_add_u32 m0, m0, s44
    s_nop 0
    buffer_load_dwordx4 v14, s[8:11], s21 offen lds
    s_add_u32 m0, s23, 11264
    s_add_u32 m0, m0, s44
    s_nop 0
    buffer_load_dwordx4 v15, s[8:11], s21 offen lds
    s_add_u32 s20, s20, 128
    s_add_u32 s21, s21, 131072
    s_add_u32 s23, s23, 24576
    s_cmp_ge_u32 s23, 147456
    s_cselect_b32 s23, 0, s23
    s_mov_b32 s22, 0
g2p_l2:
    s_waitcnt vmcnt(18)
    s_barrier
    s_add_u32 m0, s23, 0
    s_add_u32 m0, m0, s43
    s_nop 0
    buffer_load_dwordx4 v8, s[4:7], s20 offen lds
    s_add_u32 m0, s23, 1024
    s_add_u32 m0, m0, s43
    s_nop 0
    buffer_load_dwordx4 v9, s[4:7], s20 offen lds
    s_add_u32 m0, s23, 8192
    s_add_u32 m0, m0, s44
    s_nop 0
    buffer_load_dwordx4 v12, s[8:11], s21 offen lds
    s_add_u32 m0, s23, 9216
    s_add_u32 m0, m0, s44
    s_nop 0
    buffer_load_dwordx4 v13, s[8:11], s21 offen lds
    s_add_u32 m0, s23, 10240
    s_add_u32 m0, m0, s44
    s_nop 0
    buffer_load_dwordx4 v14, s[8:11], s21 offen lds
    s_add_u32 m0, s23, 11264
    s_add_u32 m0, m0, s44
    s_nop 0
    buffer_load_dwordx4 v15, s[8:11], s21 offen lds
    s_add_u32 s20, s20, 128
    s_add_u32 s21, s21, 131072
    s_add_u32 s23, s23, 24576
    s_cmp_ge_u32 s23, 147456
    s_cselect_b32 s23, 0, s23
    s_add_u32 s22, s22, 1
    s_cmp_lt_u32 s22, 55
    s_cbranch_scc1 g2p_l2
    s_waitcnt vmcnt(18)
    s_barrier
    s_waitcnt vmcnt(12)
    s_barrier
    s_waitcnt vmcnt(6)
    s_barrier
    s_waitcnt vmcnt(0)
    s_barrier
    s_branch g2_done
g2_consumer:
    s_lshr_b32 s26, s25, 1
    s_and_b32 s27, s25, 1
    s_mov_b32 s12, s36
    s_mov_b32 s13, s37
    s_mov_b32 s14, 0x400000
    s_mov_b32 s15, 0x00020000
    s_mov_b32 s16, s38
    s_mov_b32 s17, s39
    s_mov_b32 s18, 0x400000
    s_mov_b32 s19, 0x00020000
    v_and_b32 v23, 15, v22
    v_lshrrev_b32 v24, 4, v22
    v_lshrrev_b32 v25, 1, v23
    v_xor_b32 v25, v25, v24
    v_lshlrev_b32 v25, 4, v25
    v_lshlrev_b32 v26, 7, v23
    v_add_u32 v25, v25, v26
    s_lshl_b32 s40, s26, 12
    v_add_u32 v2, s40, v25
    v_xor_b32 v3, 64, v2
    v_lshrrev_b32 v23, 4, v22
    v_lshlrev_b32 v23, 2, v23
    v_and_b32 v24, 15, v22
    v_lshrrev_b32 v24, 2, v24
    v_add_u32 v23, v23, v24
    v_and_b32 v24, 7, v23
    v_lshlrev_b32 v23, 8, v23
    v_and_b32 v25, 3, v22
    v_lshlrev_b32 v25, 3, v25
    v_add_u32 v23, v23, v25
    v_add_u32 v23, 8192, v23
    s_lshl_b32 s40, s27, 2
    s_add_u32 s41, s40, 0
    v_xor_b32 v25, s41, v24
    v_lshlrev_b32 v25, 5, v25
    v_add_u32 v4, v23, v25
    s_add_u32 s41, s40, 1
    v_xor_b32 v25, s41, v24
    v_lshlrev_b32 v25, 5, v25
    v_add_u32 v5, v23, v25
    s_add_u32 s41, s40, 2
    v_xor_b32 v25, s41, v24
    v_lshlrev_b32 v25, 5, v25
    v_add_u32 v6, v23, v25
    s_add_u32 s41, s40, 3
    v_xor_b32 v25, s41, v24
    v_lshlrev_b32 v25, 5, v25
    v_add_u32 v7, v23, v25
    v_mov_b32 v152, 0
    v_mov_b32 v153, 0
    v_mov_b32 v154, 0
    v_mov_b32 v155, 0
    v_mov_b32 v156, 0
    v_mov_b32 v157, 0
    v_mov_b32 v158, 0
    v_mov_b32 v159, 0
    v_mov_b32 v160, 0
    v_mov_b32 v161, 0
    v_mov_b32 v162, 0
    v_mov_b32 v163, 0
    v_mov_b32 v164, 0
    v_mov_b32 v165, 0
    v_mov_b32 v166, 0
    v_mov_b32 v167, 0
    v_mov_b32 v168, 0
    v_mov_b32 v169, 0
    v_mov_b32 v170, 0
    v_mov_b32 v171, 0
    v_mov_b32 v172, 0
    v_mov_b32 v173, 0
    v_mov_b32 v174, 0
    v_mov_b32 v175, 0
    v_mov_b32 v176, 0
    v_mov_b32 v177, 0
    v_mov_b32 v178, 0
    v_mov_b32 v179, 0
    v_mov_b32 v180, 0
    v_mov_b32 v181, 0
    v_mov_b32 v182, 0
    v_mov_b32 v183, 0
    v_mov_b32 v184, 0
    v_mov_b32 v185, 0
    v_mov_b32 v186, 0
    v_mov_b32 v187, 0
    v_mov_b32 v188, 0
    v_mov_b32 v189, 0
    v_mov_b32 v190, 0
    v_mov_b32 v191, 0
    v_mov_b32 v192, 0
    v_mov_b32 v193, 0
    v_mov_b32 v194, 0
    v_mov_b32 v195, 0
    v_mov_b32 v196, 0
    v_mov_b32 v197, 0
    v_mov_b32 v198, 0
    v_mov_b32 v199, 0
    v_mov_b32 v200, 0
    v_mov_b32 v201, 0
    v_mov_b32 v202, 0
    v_mov_b32 v203, 0
    v_mov_b32 v204, 0
    v_mov_b32 v205, 0
    v_mov_b32 v206, 0
    v_mov_b32 v207, 0
    v_mov_b32 v208, 0
    v_mov_b32 v209, 0
    v_mov_b32 v210, 0
    v_mov_b32 v211, 0
    v_mov_b32 v212, 0
    v_mov_b32 v213, 0
    v_mov_b32 v214, 0
    v_mov_b32 v215, 0
    v_and_b32 v23, 15, v22
    v_lshrrev_b32 v24, 4, v22
    v_lshlrev_b32 v23, 11, v23
    v_lshlrev_b32 v24, 3, v24
    v_add_u32 v32, v23, v24
    s_lshl_b32 s45, s28, 17
    s_lshl_b32 s41, s26, 16
    s_add_u32 s45, s45, s41
    s_lshl_b32 s41, s29, 8
    s_add_u32 s45, s45, s41
    s_lshl_b32 s41, s27, 7
    s_add_u32 s45, s45, s41
    s_add_u32 s41, s45, 0
    buffer_load_dwordx2 v[40:41], v32, s[12:15], s41 offen
    s_add_u32 s41, s45, 32
    buffer_load_dwordx2 v[42:43], v32, s[12:15], s41 offen
    s_add_u32 s41, s45, 64
    buffer_load_dwordx2 v[44:45], v32, s[12:15], s41 offen
    s_add_u32 s41, s45, 96
    buffer_load_dwordx2 v[46:47], v32, s[12:15], s41 offen
    s_add_u32 s41, s45, 32768
    buffer_load_dwordx2 v[48:49], v32, s[12:15], s41 offen
    s_add_u32 s41, s45, 32800
    buffer_load_dwordx2 v[50:51], v32, s[12:15], s41 offen
    s_add_u32 s41, s45, 32832
    buffer_load_dwordx2 v[52:53], v32, s[12:15], s41 offen
    s_add_u32 s41, s45, 32864
    buffer_load_dwordx2 v[54:55], v32, s[12:15], s41 offen
    s_mov_b32 s24, 0
    s_barrier
    v_add_u32 v16, s24, v2
    v_add_u32 v17, s24, v3
    v_add_u32 v18, s24, v4
    v_add_u32 v19, s24, v5
    v_add_u32 v20, s24, v6
    v_add_u32 v21, s24, v7
    s_add_u32 s24, s24, 24576
    s_cmp_ge_u32 s24, 147456
    s_cselect_b32 s24, 0, s24
    ds_read_b128 v[56:59], v16 offset:0
    ds_read_b128 v[60:63], v16 offset:2048
    ds_read_b64_tr_b16 v[64:65], v18 offset:0
    ds_read_b64_tr_b16 v[66:67], v18 offset:4096
    ds_read_b64_tr_b16 v[68:69], v19 offset:0
    ds_read_b64_tr_b16 v[70:71], v19 offset:4096
    ds_read_b64_tr_b16 v[72:73], v20 offset:0
    ds_read_b64_tr_b16 v[74:75], v20 offset:4096
    ds_read_b64_tr_b16 v[76:77], v21 offset:0
    ds_read_b64_tr_b16 v[78:79], v21 offset:4096
    ds_read_b128 v[80:83], v17 offset:0
    ds_read_b128 v[84:87], v17 offset:2048
    ds_read_b64_tr_b16 v[88:89], v18 offset:8192
    ds_read_b64_tr_b16 v[90:91], v18 offset:12288
    ds_read_b64_tr_b16 v[92:93], v19 offset:8192
    ds_read_b64_tr_b16 v[94:95], v19 offset:12288
    ds_read_b64_tr_b16 v[96:97], v20 offset:8192
    ds_read_b64_tr_b16 v[98:99], v20 offset:12288
    ds_read_b64_tr_b16 v[100:101], v21 offset:8192
    ds_read_b64_tr_b16 v[102:103], v21 offset:12288
    s_mov_b32 s22, 0
g2c_l1:
    s_barrier
    s_waitcnt lgkmcnt(0)
    v_add_u32 v16, s24, v2
    v_add_u32 v17, s24, v3
    v_add_u32 v18, s24, v4
    v_add_u32 v19, s24, v5
    v_add_u32 v20, s24, v6
    v_add_u32 v21, s24, v7
    s_add_u32 s24, s24, 24576
    s_cmp_ge_u32 s24, 147456
    s_cselect_b32 s24, 0, s24
    v_mfma_f32_16x16x32_bf16 v[152:155], v[64:67], v[56:59], v[152:155]
    ds_read_b128 v[104:107], v16 offset:0
    ds_read_b128 v[108:111], v16 offset:2048
    v_mfma_f32_16x16x32_bf16 v[156:159], v[68:71], v[56:59], v[156:159]
    ds_read_b64_tr_b16 v[112:113], v18 offset:0
    ds_read_b64_tr_b16 v[114:115], v18 offset:4096
    v_mfma_f32_16x16x32_bf16 v[160:163], v[72:75], v[56:59], v[160:163]
    ds_read_b64_tr_b16 v[116:117], v19 offset:0
    ds_read_b64_tr_b16 v[118:119], v19 offset:4096
    v_mfma_f32_16x16x32_bf16 v[164:167], v[76:79], v[56:59], v[164:167]
    ds_read_b64_tr_b16 v[120:121], v20 offset:0
    ds_read_b64_tr_b16 v[122:123], v20 offset:4096
    v_mfma_f32_16x16x32_bf16 v[168:171], v[64:67], v[60:63], v[168:171]
    ds_read_b64_tr_b16 v[124:125], v21 offset:0
    v_mfma_f32_16x16x32_bf16 v[172:175], v[68:71], v[60:63], v[172:175]
    ds_read_b64_tr_b16 v[126:127], v21 offset:4096
    v_mfma_f32_16x16x32_bf16 v[176:179], v[72:75], v[60:63], v[176:179]
    ds_read_b128 v[128:131], v17 offset:0
    v_mfma_f32_16x16x32_bf16 v[180:183], v[76:79], v[60:63], v[180:183]
    ds_read_b128 v[132:135], v17 offset:2048
    v_mfma_f32_16x16x32_bf16 v[152:155], v[88:91], v[80:83], v[152:155]
    ds_read_b64_tr_b16 v[136:137], v18 offset:8192
    v_mfma_f32_16x16x32_bf16 v[156:159], v[92:95], v[80:83], v[156:159]
    ds_read_b64_tr_b16 v[138:139], v18 offset:12288
    v_mfma_f32_16x16x32_bf16 v[160:163], v[96:99], v[80:83], v[160:163]
    ds_read_b64_tr_b16 v[140:141], v19 offset:8192
    v_mfma_f32_16x16x32_bf16 v[164:167], v[100:103], v[80:83], v[164:167]
    ds_read_b64_tr_b16 v[142:143], v19 offset:12288
    v_mfma_f32_16x16x32_bf16 v[168:171], v[88:91], v[84:87], v[168:171]
    ds_read_b64_tr_b16 v[144:145], v20 offset:8192
    v_mfma_f32_16x16x32_bf16 v[172:175], v[92:95], v[84:87], v[172:175]
    ds_read_b64_tr_b16 v[146:147], v20 offset:12288
    v_mfma_f32_16x16x32_bf16 v[176:179], v[96:99], v[84:87], v[176:179]
    ds_read_b64_tr_b16 v[148:149], v21 offset:8192
    v_mfma_f32_16x16x32_bf16 v[180:183], v[100:103], v[84:87], v[180:183]
    ds_read_b64_tr_b16 v[150:151], v21 offset:12288
    s_barrier
    s_waitcnt lgkmcnt(0)
    v_add_u32 v16, s24, v2
    v_add_u32 v17, s24, v3
    v_add_u32 v18, s24, v4
    v_add_u32 v19, s24, v5
    v_add_u32 v20, s24, v6
    v_add_u32 v21, s24, v7
    s_add_u32 s24, s24, 24576
    s_cmp_ge_u32 s24, 147456
    s_cselect_b32 s24, 0, s24
    v_mfma_f32_16x16x32_bf16 v[152:155], v[112:115], v[104:107], v[152:155]
    ds_read_b128 v[56:59], v16 offset:0
    ds_read_b128 v[60:63], v16 offset:2048
    v_mfma_f32_16x16x32_bf16 v[156:159], v[116:119], v[104:107], v[156:159]
    ds_read_b64_tr_b16 v[64:65], v18 offset:0
    ds_read_b64_tr_b16 v[66:67], v18 offset:4096
    v_mfma_f32_16x16x32_bf16 v[160:163], v[120:123], v[104:107], v[160:163]
    ds_read_b64_tr_b16 v[68:69], v19 offset:0
    ds_read_b64_tr_b16 v[70:71], v19 offset:4096
    v_mfma_f32_16x16x32_bf16 v[164:167], v[124:127], v[104:107], v[164:167]
    ds_read_b64_tr_b16 v[72:73], v20 offset:0
    ds_read_b64_tr_b16 v[74:75], v20 offset:4096
    v_mfma_f32_16x16x32_bf16 v[168:171], v[112:115], v[108:111], v[168:171]
    ds_read_b64_tr_b16 v[76:77], v21 offset:0
    v_mfma_f32_16x16x32_bf16 v[172:175], v[116:119], v[108:111], v[172:175]
    ds_read_b64_tr_b16 v[78:79], v21 offset:4096
    v_mfma_f32_16x16x32_bf16 v[176:179], v[120:123], v[108:111], v[176:179]
    ds_read_b128 v[80:83], v17 offset:0
    v_mfma_f32_16x16x32_bf16 v[180:183], v[124:127], v[108:111], v[180:183]
    ds_read_b128 v[84:87], v17 offset:2048
    v_mfma_f32_16x16x32_bf16 v[152:155], v[136:139], v[128:131], v[152:155]
    ds_read_b64_tr_b16 v[88:89], v18 offset:8192
    v_mfma_f32_16x16x32_bf16 v[156:159], v[140:143], v[128:131], v[156:159]
    ds_read_b64_tr_b16 v[90:91], v18 offset:12288
    v_mfma_f32_16x16x32_bf16 v[160:163], v[144:147], v[128:131], v[160:163]
    ds_read_b64_tr_b16 v[92:93], v19 offset:8192
    v_mfma_f32_16x16x32_bf16 v[164:167], v[148:151], v[128:131], v[164:167]
    ds_read_b64_tr_b16 v[94:95], v19 offset:12288
    v_mfma_f32_16x16x32_bf16 v[168:171], v[136:139], v[132:135], v[168:171]
    ds_read_b64_tr_b16 v[96:97], v20 offset:8192
    v_mfma_f32_16x16x32_bf16 v[172:175], v[140:143], v[132:135], v[172:175]
    ds_read_b64_tr_b16 v[98:99], v20 offset:12288
    v_mfma_f32_16x16x32_bf16 v[176:179], v[144:147], v[132:135], v[176:179]
    ds_read_b64_tr_b16 v[100:101], v21 offset:8192
    v_mfma_f32_16x16x32_bf16 v[180:183], v[148:151], v[132:135], v[180:183]
    ds_read_b64_tr_b16 v[102:103], v21 offset:12288
    s_add_u32 s22, s22, 1
    s_cmp_lt_u32 s22, 8
    s_cbranch_scc1 g2c_l1
    s_mov_b32 s22, 0
g2c_l2:
    s_barrier
    s_waitcnt lgkmcnt(0)
    v_add_u32 v16, s24, v2
    v_add_u32 v17, s24, v3
    v_add_u32 v18, s24, v4
    v_add_u32 v19, s24, v5
    v_add_u32 v20, s24, v6
    v_add_u32 v21, s24, v7
    s_add_u32 s24, s24, 24576
    s_cmp_ge_u32 s24, 147456
    s_cselect_b32 s24, 0, s24
    v_mfma_f32_16x16x32_bf16 v[184:187], v[64:67], v[56:59], v[184:187]
    ds_read_b128 v[104:107], v16 offset:0
    ds_read_b128 v[108:111], v16 offset:2048
    v_mfma_f32_16x16x32_bf16 v[188:191], v[68:71], v[56:59], v[188:191]
    ds_read_b64_tr_b16 v[112:113], v18 offset:0
    ds_read_b64_tr_b16 v[114:115], v18 offset:4096
    v_mfma_f32_16x16x32_bf16 v[192:195], v[72:75], v[56:59], v[192:195]
    ds_read_b64_tr_b16 v[116:117], v19 offset:0
    ds_read_b64_tr_b16 v[118:119], v19 offset:4096
    v_mfma_f32_16x16x32_bf16 v[196:199], v[76:79], v[56:59], v[196:199]
    ds_read_b64_tr_b16 v[120:121], v20 offset:0
    ds_read_b64_tr_b16 v[122:123], v20 offset:4096
    v_mfma_f32_16x16x32_bf16 v[200:203], v[64:67], v[60:63], v[200:203]
    ds_read_b64_tr_b16 v[124:125], v21 offset:0
    v_mfma_f32_16x16x32_bf16 v[204:207], v[68:71], v[60:63], v[204:207]
    ds_read_b64_tr_b16 v[126:127], v21 offset:4096
    v_mfma_f32_16x16x32_bf16 v[208:211], v[72:75], v[60:63], v[208:211]
    ds_read_b128 v[128:131], v17 offset:0
    v_mfma_f32_16x16x32_bf16 v[212:215], v[76:79], v[60:63], v[212:215]
    ds_read_b128 v[132:135], v17 offset:2048
    v_mfma_f32_16x16x32_bf16 v[184:187], v[88:91], v[80:83], v[184:187]
    ds_read_b64_tr_b16 v[136:137], v18 offset:8192
    v_mfma_f32_16x16x32_bf16 v[188:191], v[92:95], v[80:83], v[188:191]
    ds_read_b64_tr_b16 v[138:139], v18 offset:12288
    v_mfma_f32_16x16x32_bf16 v[192:195], v[96:99], v[80:83], v[192:195]
    ds_read_b64_tr_b16 v[140:141], v19 offset:8192
    v_mfma_f32_16x16x32_bf16 v[196:199], v[100:103], v[80:83], v[196:199]
    ds_read_b64_tr_b16 v[142:143], v19 offset:12288
    v_mfma_f32_16x16x32_bf16 v[200:203], v[88:91], v[84:87], v[200:203]
    ds_read_b64_tr_b16 v[144:145], v20 offset:8192
    v_mfma_f32_16x16x32_bf16 v[204:207], v[92:95], v[84:87], v[204:207]
    ds_read_b64_tr_b16 v[146:147], v20 offset:12288
    v_mfma_f32_16x16x32_bf16 v[208:211], v[96:99], v[84:87], v[208:211]
    ds_read_b64_tr_b16 v[148:149], v21 offset:8192
    v_mfma_f32_16x16x32_bf16 v[212:215], v[100:103], v[84:87], v[212:215]
    ds_read_b64_tr_b16 v[150:151], v21 offset:12288
    s_barrier
    s_waitcnt lgkmcnt(0)
    v_add_u32 v16, s24, v2
    v_add_u32 v17, s24, v3
    v_add_u32 v18, s24, v4
    v_add_u32 v19, s24, v5
    v_add_u32 v20, s24, v6
    v_add_u32 v21, s24, v7
    s_add_u32 s24, s24, 24576
    s_cmp_ge_u32 s24, 147456
    s_cselect_b32 s24, 0, s24
    v_mfma_f32_16x16x32_bf16 v[184:187], v[112:115], v[104:107], v[184:187]
    ds_read_b128 v[56:59], v16 offset:0
    ds_read_b128 v[60:63], v16 offset:2048
    v_mfma_f32_16x16x32_bf16 v[188:191], v[116:119], v[104:107], v[188:191]
    ds_read_b64_tr_b16 v[64:65], v18 offset:0
    ds_read_b64_tr_b16 v[66:67], v18 offset:4096
    v_mfma_f32_16x16x32_bf16 v[192:195], v[120:123], v[104:107], v[192:195]
    ds_read_b64_tr_b16 v[68:69], v19 offset:0
    ds_read_b64_tr_b16 v[70:71], v19 offset:4096
    v_mfma_f32_16x16x32_bf16 v[196:199], v[124:127], v[104:107], v[196:199]
    ds_read_b64_tr_b16 v[72:73], v20 offset:0
    ds_read_b64_tr_b16 v[74:75], v20 offset:4096
    v_mfma_f32_16x16x32_bf16 v[200:203], v[112:115], v[108:111], v[200:203]
    ds_read_b64_tr_b16 v[76:77], v21 offset:0
    v_mfma_f32_16x16x32_bf16 v[204:207], v[116:119], v[108:111], v[204:207]
    ds_read_b64_tr_b16 v[78:79], v21 offset:4096
    v_mfma_f32_16x16x32_bf16 v[208:211], v[120:123], v[108:111], v[208:211]
    ds_read_b128 v[80:83], v17 offset:0
    v_mfma_f32_16x16x32_bf16 v[212:215], v[124:127], v[108:111], v[212:215]
    ds_read_b128 v[84:87], v17 offset:2048
    v_mfma_f32_16x16x32_bf16 v[184:187], v[136:139], v[128:131], v[184:187]
    ds_read_b64_tr_b16 v[88:89], v18 offset:8192
    v_mfma_f32_16x16x32_bf16 v[188:191], v[140:143], v[128:131], v[188:191]
    ds_read_b64_tr_b16 v[90:91], v18 offset:12288
    v_mfma_f32_16x16x32_bf16 v[192:195], v[144:147], v[128:131], v[192:195]
    ds_read_b64_tr_b16 v[92:93], v19 offset:8192
    v_mfma_f32_16x16x32_bf16 v[196:199], v[148:151], v[128:131], v[196:199]
    ds_read_b64_tr_b16 v[94:95], v19 offset:12288
    v_mfma_f32_16x16x32_bf16 v[200:203], v[136:139], v[132:135], v[200:203]
    ds_read_b64_tr_b16 v[96:97], v20 offset:8192
    v_mfma_f32_16x16x32_bf16 v[204:207], v[140:143], v[132:135], v[204:207]
    ds_read_b64_tr_b16 v[98:99], v20 offset:12288
    v_mfma_f32_16x16x32_bf16 v[208:211], v[144:147], v[132:135], v[208:211]
    ds_read_b64_tr_b16 v[100:101], v21 offset:8192
    v_mfma_f32_16x16x32_bf16 v[212:215], v[148:151], v[132:135], v[212:215]
    ds_read_b64_tr_b16 v[102:103], v21 offset:12288
    s_add_u32 s22, s22, 1
    s_cmp_lt_u32 s22, 27
    s_cbranch_scc1 g2c_l2
    s_barrier
    s_waitcnt lgkmcnt(0)
    v_add_u32 v16, s24, v2
    v_add_u32 v17, s24, v3
    v_add_u32 v18, s24, v4
    v_add_u32 v19, s24, v5
    v_add_u32 v20, s24, v6
    v_add_u32 v21, s24, v7
    s_add_u32 s24, s24, 24576
    s_cmp_ge_u32 s24, 147456
    s_cselect_b32 s24, 0, s24
    v_mfma_f32_16x16x32_bf16 v[184:187], v[64:67], v[56:59], v[184:187]
    ds_read_b128 v[104:107], v16 offset:0
    ds_read_b128 v[108:111], v16 offset:2048
    v_mfma_f32_16x16x32_bf16 v[188:191], v[68:71], v[56:59], v[188:191]
    ds_read_b64_tr_b16 v[112:113], v18 offset:0
    ds_read_b64_tr_b16 v[114:115], v18 offset:4096
    v_mfma_f32_16x16x32_bf16 v[192:195], v[72:75], v[56:59], v[192:195]
    ds_read_b64_tr_b16 v[116:117], v19 offset:0
    ds_read_b64_tr_b16 v[118:119], v19 offset:4096
    v_mfma_f32_16x16x32_bf16 v[196:199], v[76:79], v[56:59], v[196:199]
    ds_read_b64_tr_b16 v[120:121], v20 offset:0
    ds_read_b64_tr_b16 v[122:123], v20 offset:4096
    v_mfma_f32_16x16x32_bf16 v[200:203], v[64:67], v[60:63], v[200:203]
    ds_read_b64_tr_b16 v[124:125], v21 offset:0
    v_mfma_f32_16x16x32_bf16 v[204:207], v[68:71], v[60:63], v[204:207]
    ds_read_b64_tr_b16 v[126:127], v21 offset:4096
    v_mfma_f32_16x16x32_bf16 v[208:211], v[72:75], v[60:63], v[208:211]
    ds_read_b128 v[128:131], v17 offset:0
    v_mfma_f32_16x16x32_bf16 v[212:215], v[76:79], v[60:63], v[212:215]
    ds_read_b128 v[132:135], v17 offset:2048
    v_mfma_f32_16x16x32_bf16 v[184:187], v[88:91], v[80:83], v[184:187]
    ds_read_b64_tr_b16 v[136:137], v18 offset:8192
    v_mfma_f32_16x16x32_bf16 v[188:191], v[92:95], v[80:83], v[188:191]
    ds_read_b64_tr_b16 v[138:139], v18 offset:12288
    v_mfma_f32_16x16x32_bf16 v[192:195], v[96:99], v[80:83], v[192:195]
    ds_read_b64_tr_b16 v[140:141], v19 offset:8192
    v_mfma_f32_16x16x32_bf16 v[196:199], v[100:103], v[80:83], v[196:199]
    ds_read_b64_tr_b16 v[142:143], v19 offset:12288
    v_mfma_f32_16x16x32_bf16 v[200:203], v[88:91], v[84:87], v[200:203]
    ds_read_b64_tr_b16 v[144:145], v20 offset:8192
    v_mfma_f32_16x16x32_bf16 v[204:207], v[92:95], v[84:87], v[204:207]
    ds_read_b64_tr_b16 v[146:147], v20 offset:12288
    v_mfma_f32_16x16x32_bf16 v[208:211], v[96:99], v[84:87], v[208:211]
    ds_read_b64_tr_b16 v[148:149], v21 offset:8192
    v_mfma_f32_16x16x32_bf16 v[212:215], v[100:103], v[84:87], v[212:215]
    ds_read_b64_tr_b16 v[150:151], v21 offset:12288
    s_waitcnt lgkmcnt(0)
    v_mfma_f32_16x16x32_bf16 v[184:187], v[112:115], v[104:107], v[184:187]
    v_mfma_f32_16x16x32_bf16 v[188:191], v[116:119], v[104:107], v[188:191]
    v_mfma_f32_16x16x32_bf16 v[192:195], v[120:123], v[104:107], v[192:195]
    v_mfma_f32_16x16x32_bf16 v[196:199], v[124:127], v[104:107], v[196:199]
    v_mfma_f32_16x16x32_bf16 v[200:203], v[112:115], v[108:111], v[200:203]
    v_mfma_f32_16x16x32_bf16 v[204:207], v[116:119], v[108:111], v[204:207]
    v_mfma_f32_16x16x32_bf16 v[208:211], v[120:123], v[108:111], v[208:211]
    v_mfma_f32_16x16x32_bf16 v[212:215], v[124:127], v[108:111], v[212:215]
    v_mfma_f32_16x16x32_bf16 v[184:187], v[136:139], v[128:131], v[184:187]
    v_mfma_f32_16x16x32_bf16 v[188:191], v[140:143], v[128:131], v[188:191]
    v_mfma_f32_16x16x32_bf16 v[192:195], v[144:147], v[128:131], v[192:195]
    v_mfma_f32_16x16x32_bf16 v[196:199], v[148:151], v[128:131], v[196:199]
    v_mfma_f32_16x16x32_bf16 v[200:203], v[136:139], v[132:135], v[200:203]
    v_mfma_f32_16x16x32_bf16 v[204:207], v[140:143], v[132:135], v[204:207]
    v_mfma_f32_16x16x32_bf16 v[208:211], v[144:147], v[132:135], v[208:211]
    v_mfma_f32_16x16x32_bf16 v[212:215], v[148:151], v[132:135], v[212:215]
    s_nop 7
    s_nop 7
    s_mov_b32 s42, 0xbfb8aa3b
    s_waitcnt vmcnt(0)
    v_cvt_pk_bf16_f32 v66, v152, v153
    v_cvt_pk_bf16_f32 v67, v184, v185
    s_nop 0
    v_lshlrev_b32 v60, 16, v66
    v_and_b32 v61, 0xffff0000, v66
    v_lshlrev_b32 v62, 16, v67
    v_and_b32 v63, 0xffff0000, v67
    v_mul_f32 v64, s42, v62
    v_mul_f32 v65, s42, v63
    v_exp_f32 v64, v64
    v_exp_f32 v65, v65
    s_nop 0
    v_add_f32 v64, 1.0, v64
    v_add_f32 v65, 1.0, v65
    v_rcp_f32 v64, v64
    v_rcp_f32 v65, v65
    s_nop 0
    v_mul_f32 v62, v62, v64
    v_mul_f32 v63, v63, v65
    v_cvt_pk_bf16_f32 v66, v62, v63
    s_nop 0
    v_lshlrev_b32 v62, 16, v66
    v_and_b32 v63, 0xffff0000, v66
    v_mul_f32 v60, v60, v62
    v_mul_f32 v61, v61, v63
    v_cvt_pk_bf16_f32 v66, v60, v61
    s_nop 0
    v_lshlrev_b32 v60, 16, v66
    v_and_b32 v61, 0xffff0000, v66
    v_lshlrev_b32 v64, 16, v40
    v_and_b32 v65, 0xffff0000, v40
    v_add_f32 v60, v60, v64
    v_add_f32 v61, v61, v65
    v_cvt_pk_bf16_f32 v72, v60, v61
    v_cvt_pk_bf16_f32 v66, v154, v155
    v_cvt_pk_bf16_f32 v67, v186, v187
    s_nop 0
    v_lshlrev_b32 v60, 16, v66
    v_and_b32 v61, 0xffff0000, v66
    v_lshlrev_b32 v62, 16, v67
    v_and_b32 v63, 0xffff0000, v67
    v_mul_f32 v64, s42, v62
    v_mul_f32 v65, s42, v63
    v_exp_f32 v64, v64
    v_exp_f32 v65, v65
    s_nop 0
    v_add_f32 v64, 1.0, v64
    v_add_f32 v65, 1.0, v65
    v_rcp_f32 v64, v64
    v_rcp_f32 v65, v65
    s_nop 0
    v_mul_f32 v62, v62, v64
    v_mul_f32 v63, v63, v65
    v_cvt_pk_bf16_f32 v66, v62, v63
    s_nop 0
    v_lshlrev_b32 v62, 16, v66
    v_and_b32 v63, 0xffff0000, v66
    v_mul_f32 v60, v60, v62
    v_mul_f32 v61, v61, v63
    v_cvt_pk_bf16_f32 v66, v60, v61
    s_nop 0
    v_lshlrev_b32 v60, 16, v66
    v_and_b32 v61, 0xffff0000, v66
    v_lshlrev_b32 v64, 16, v41
    v_and_b32 v65, 0xffff0000, v41
    v_add_f32 v60, v60, v64
    v_add_f32 v61, v61, v65
    v_cvt_pk_bf16_f32 v73, v60, v61
    s_add_u32 s41, s45, 0
    s_nop 0
    buffer_store_dwordx2 v[72:73], v32, s[16:19], s41 offen
    v_cvt_pk_bf16_f32 v66, v156, v157
    v_cvt_pk_bf16_f32 v67, v188, v189
    s_nop 0
    v_lshlrev_b32 v60, 16, v66
    v_and_b32 v61, 0xffff0000, v66
    v_lshlrev_b32 v62, 16, v67
    v_and_b32 v63, 0xffff0000, v67
    v_mul_f32 v64, s42, v62
    v_mul_f32 v65, s42, v63
    v_exp_f32 v64, v64
    v_exp_f32 v65, v65
    s_nop 0
    v_add_f32 v64, 1.0, v64
    v_add_f32 v65, 1.0, v65
    v_rcp_f32 v64, v64
    v_rcp_f32 v65, v65
    s_nop 0
    v_mul_f32 v62, v62, v64
    v_mul_f32 v63, v63, v65
    v_cvt_pk_bf16_f32 v66, v62, v63
    s_nop 0
    v_lshlrev_b32 v62, 16, v66
    v_and_b32 v63, 0xffff0000, v66
    v_mul_f32 v60, v60, v62
    v_mul_f32 v61, v61, v63
    v_cvt_pk_bf16_f32 v66, v60, v61
    s_nop 0
    v_lshlrev_b32 v60, 16, v66
    v_and_b32 v61, 0xffff0000, v66
    v_lshlrev_b32 v64, 16, v42
    v_and_b32 v65, 0xffff0000, v42
    v_add_f32 v60, v60, v64
    v_add_f32 v61, v61, v65
    v_cvt_pk_bf16_f32 v74, v60, v61
    v_cvt_pk_bf16_f32 v66, v158, v159
    v_cvt_pk_bf16_f32 v67, v190, v191
    s_nop 0
    v_lshlrev_b32 v60, 16, v66
    v_and_b32 v61, 0xffff0000, v66
    v_lshlrev_b32 v62, 16, v67
    v_and_b32 v63, 0xffff0000, v67
    v_mul_f32 v64, s42, v62
    v_mul_f32 v65, s42, v63
    v_exp_f32 v64, v64
    v_exp_f32 v65, v65
    s_nop 0
    v_add_f32 v64, 1.0, v64
    v_add_f32 v65, 1.0, v65
    v_rcp_f32 v64, v64
    v_rcp_f32 v65, v65
    s_nop 0
    v_mul_f32 v62, v62, v64
    v_mul_f32 v63, v63, v65
    v_cvt_pk_bf16_f32 v66, v62, v63
    s_nop 0
    v_lshlrev_b32 v62, 16, v66
    v_and_b32 v63, 0xffff0000, v66
    v_mul_f32 v60, v60, v62
    v_mul_f32 v61, v61, v63
    v_cvt_pk_bf16_f32 v66, v60, v61
    s_nop 0
    v_lshlrev_b32 v60, 16, v66
    v_and_b32 v61, 0xffff0000, v66
    v_lshlrev_b32 v64, 16, v43
    v_and_b32 v65, 0xffff0000, v43
    v_add_f32 v60, v60, v64
    v_add_f32 v61, v61, v65
    v_cvt_pk_bf16_f32 v75, v60, v61
    s_add_u32 s41, s45, 32
    s_nop 0
    buffer_store_dwordx2 v[74:75], v32, s[16:19], s41 offen
    v_cvt_pk_bf16_f32 v66, v160, v161
    v_cvt_pk_bf16_f32 v67, v192, v193
    s_nop 0
    v_lshlrev_b32 v60, 16, v66
    v_and_b32 v61, 0xffff0000, v66
    v_lshlrev_b32 v62, 16, v67
    v_and_b32 v63, 0xffff0000, v67
    v_mul_f32 v64, s42, v62
    v_mul_f32 v65, s42, v63
    v_exp_f32 v64, v64
    v_exp_f32 v65, v65
    s_nop 0
    v_add_f32 v64, 1.0, v64
    v_add_f32 v65, 1.0, v65
    v_rcp_f32 v64, v64
    v_rcp_f32 v65, v65
    s_nop 0
    v_mul_f32 v62, v62, v64
    v_mul_f32 v63, v63, v65
    v_cvt_pk_bf16_f32 v66, v62, v63
    s_nop 0
    v_lshlrev_b32 v62, 16, v66
    v_and_b32 v63, 0xffff0000, v66
    v_mul_f32 v60, v60, v62
    v_mul_f32 v61, v61, v63
    v_cvt_pk_bf16_f32 v66, v60, v61
    s_nop 0
    v_lshlrev_b32 v60, 16, v66
    v_and_b32 v61, 0xffff0000, v66
    v_lshlrev_b32 v64, 16, v44
    v_and_b32 v65, 0xffff0000, v44
    v_add_f32 v60, v60, v64
    v_add_f32 v61, v61, v65
    v_cvt_pk_bf16_f32 v76, v60, v61
    v_cvt_pk_bf16_f32 v66, v162, v163
    v_cvt_pk_bf16_f32 v67, v194, v195
    s_nop 0
    v_lshlrev_b32 v60, 16, v66
    v_and_b32 v61, 0xffff0000, v66
    v_lshlrev_b32 v62, 16, v67
    v_and_b32 v63, 0xffff0000, v67
    v_mul_f32 v64, s42, v62
    v_mul_f32 v65, s42, v63
    v_exp_f32 v64, v64
    v_exp_f32 v65, v65
    s_nop 0
    v_add_f32 v64, 1.0, v64
    v_add_f32 v65, 1.0, v65
    v_rcp_f32 v64, v64
    v_rcp_f32 v65, v65
    s_nop 0
    v_mul_f32 v62, v62, v64
    v_mul_f32 v63, v63, v65
    v_cvt_pk_bf16_f32 v66, v62, v63
    s_nop 0
    v_lshlrev_b32 v62, 16, v66
    v_and_b32 v63, 0xffff0000, v66
    v_mul_f32 v60, v60, v62
    v_mul_f32 v61, v61, v63
    v_cvt_pk_bf16_f32 v66, v60, v61
    s_nop 0
    v_lshlrev_b32 v60, 16, v66
    v_and_b32 v61, 0xffff0000, v66
    v_lshlrev_b32 v64, 16, v45
    v_and_b32 v65, 0xffff0000, v45
    v_add_f32 v60, v60, v64
    v_add_f32 v61, v61, v65
    v_cvt_pk_bf16_f32 v77, v60, v61
    s_add_u32 s41, s45, 64
    s_nop 0
    buffer_store_dwordx2 v[76:77], v32, s[16:19], s41 offen
    v_cvt_pk_bf16_f32 v66, v164, v165
    v_cvt_pk_bf16_f32 v67, v196, v197
    s_nop 0
    v_lshlrev_b32 v60, 16, v66
    v_and_b32 v61, 0xffff0000, v66
    v_lshlrev_b32 v62, 16, v67
    v_and_b32 v63, 0xffff0000, v67
    v_mul_f32 v64, s42, v62
    v_mul_f32 v65, s42, v63
    v_exp_f32 v64, v64
    v_exp_f32 v65, v65
    s_nop 0
    v_add_f32 v64, 1.0, v64
    v_add_f32 v65, 1.0, v65
    v_rcp_f32 v64, v64
    v_rcp_f32 v65, v65
    s_nop 0
    v_mul_f32 v62, v62, v64
    v_mul_f32 v63, v63, v65
    v_cvt_pk_bf16_f32 v66, v62, v63
    s_nop 0
    v_lshlrev_b32 v62, 16, v66
    v_and_b32 v63, 0xffff0000, v66
    v_mul_f32 v60, v60, v62
    v_mul_f32 v61, v61, v63
    v_cvt_pk_bf16_f32 v66, v60, v61
    s_nop 0
    v_lshlrev_b32 v60, 16, v66
    v_and_b32 v61, 0xffff0000, v66
    v_lshlrev_b32 v64, 16, v46
    v_and_b32 v65, 0xffff0000, v46
    v_add_f32 v60, v60, v64
    v_add_f32 v61, v61, v65
    v_cvt_pk_bf16_f32 v78, v60, v61
    v_cvt_pk_bf16_f32 v66, v166, v167
    v_cvt_pk_bf16_f32 v67, v198, v199
    s_nop 0
    v_lshlrev_b32 v60, 16, v66
    v_and_b32 v61, 0xffff0000, v66
    v_lshlrev_b32 v62, 16, v67
    v_and_b32 v63, 0xffff0000, v67
    v_mul_f32 v64, s42, v62
    v_mul_f32 v65, s42, v63
    v_exp_f32 v64, v64
    v_exp_f32 v65, v65
    s_nop 0
    v_add_f32 v64, 1.0, v64
    v_add_f32 v65, 1.0, v65
    v_rcp_f32 v64, v64
    v_rcp_f32 v65, v65
    s_nop 0
    v_mul_f32 v62, v62, v64
    v_mul_f32 v63, v63, v65
    v_cvt_pk_bf16_f32 v66, v62, v63
    s_nop 0
    v_lshlrev_b32 v62, 16, v66
    v_and_b32 v63, 0xffff0000, v66
    v_mul_f32 v60, v60, v62
    v_mul_f32 v61, v61, v63
    v_cvt_pk_bf16_f32 v66, v60, v61
    s_nop 0
    v_lshlrev_b32 v60, 16, v66
    v_and_b32 v61, 0xffff0000, v66
    v_lshlrev_b32 v64, 16, v47
    v_and_b32 v65, 0xffff0000, v47
    v_add_f32 v60, v60, v64
    v_add_f32 v61, v61, v65
    v_cvt_pk_bf16_f32 v79, v60, v61
    s_add_u32 s41, s45, 96
    s_nop 0
    buffer_store_dwordx2 v[78:79], v32, s[16:19], s41 offen
    v_cvt_pk_bf16_f32 v66, v168, v169
    v_cvt_pk_bf16_f32 v67, v200, v201
    s_nop 0
    v_lshlrev_b32 v60, 16, v66
    v_and_b32 v61, 0xffff0000, v66
    v_lshlrev_b32 v62, 16, v67
    v_and_b32 v63, 0xffff0000, v67
    v_mul_f32 v64, s42, v62
    v_mul_f32 v65, s42, v63
    v_exp_f32 v64, v64
    v_exp_f32 v65, v65
    s_nop 0
    v_add_f32 v64, 1.0, v64
    v_add_f32 v65, 1.0, v65
    v_rcp_f32 v64, v64
    v_rcp_f32 v65, v65
    s_nop 0
    v_mul_f32 v62, v62, v64
    v_mul_f32 v63, v63, v65
    v_cvt_pk_bf16_f32 v66, v62, v63
    s_nop 0
    v_lshlrev_b32 v62, 16, v66
    v_and_b32 v63, 0xffff0000, v66
    v_mul_f32 v60, v60, v62
    v_mul_f32 v61, v61, v63
    v_cvt_pk_bf16_f32 v66, v60, v61
    s_nop 0
    v_lshlrev_b32 v60, 16, v66
    v_and_b32 v61, 0xffff0000, v66
    v_lshlrev_b32 v64, 16, v48
    v_and_b32 v65, 0xffff0000, v48
    v_add_f32 v60, v60, v64
    v_add_f32 v61, v61, v65
    v_cvt_pk_bf16_f32 v72, v60, v61
    v_cvt_pk_bf16_f32 v66, v170, v171
    v_cvt_pk_bf16_f32 v67, v202, v203
    s_nop 0
    v_lshlrev_b32 v60, 16, v66
    v_and_b32 v61, 0xffff0000, v66
    v_lshlrev_b32 v62, 16, v67
    v_and_b32 v63, 0xffff0000, v67
    v_mul_f32 v64, s42, v62
    v_mul_f32 v65, s42, v63
    v_exp_f32 v64, v64
    v_exp_f32 v65, v65
    s_nop 0
    v_add_f32 v64, 1.0, v64
    v_add_f32 v65, 1.0, v65
    v_rcp_f32 v64, v64
    v_rcp_f32 v65, v65
    s_nop 0
    v_mul_f32 v62, v62, v64
    v_mul_f32 v63, v63, v65
    v_cvt_pk_bf16_f32 v66, v62, v63
    s_nop 0
    v_lshlrev_b32 v62, 16, v66
    v_and_b32 v63, 0xffff0000, v66
    v_mul_f32 v60, v60, v62
    v_mul_f32 v61, v61, v63
    v_cvt_pk_bf16_f32 v66, v60, v61
    s_nop 0
    v_lshlrev_b32 v60, 16, v66
    v_and_b32 v61, 0xffff0000, v66
    v_lshlrev_b32 v64, 16, v49
    v_and_b32 v65, 0xffff0000, v49
    v_add_f32 v60, v60, v64
    v_add_f32 v61, v61, v65
    v_cvt_pk_bf16_f32 v73, v60, v61
    s_add_u32 s41, s45, 32768
    s_nop 0
    buffer_store_dwordx2 v[72:73], v32, s[16:19], s41 offen
    v_cvt_pk_bf16_f32 v66, v172, v173
    v_cvt_pk_bf16_f32 v67, v204, v205
    s_nop 0
    v_lshlrev_b32 v60, 16, v66
    v_and_b32 v61, 0xffff0000, v66
    v_lshlrev_b32 v62, 16, v67
    v_and_b32 v63, 0xffff0000, v67
    v_mul_f32 v64, s42, v62
    v_mul_f32 v65, s42, v63
    v_exp_f32 v64, v64
    v_exp_f32 v65, v65
    s_nop 0
    v_add_f32 v64, 1.0, v64
    v_add_f32 v65, 1.0, v65
    v_rcp_f32 v64, v64
    v_rcp_f32 v65, v65
    s_nop 0
    v_mul_f32 v62, v62, v64
    v_mul_f32 v63, v63, v65
    v_cvt_pk_bf16_f32 v66, v62, v63
    s_nop 0
    v_lshlrev_b32 v62, 16, v66
    v_and_b32 v63, 0xffff0000, v66
    v_mul_f32 v60, v60, v62
    v_mul_f32 v61, v61, v63
    v_cvt_pk_bf16_f32 v66, v60, v61
    s_nop 0
    v_lshlrev_b32 v60, 16, v66
    v_and_b32 v61, 0xffff0000, v66
    v_lshlrev_b32 v64, 16, v50
    v_and_b32 v65, 0xffff0000, v50
    v_add_f32 v60, v60, v64
    v_add_f32 v61, v61, v65
    v_cvt_pk_bf16_f32 v74, v60, v61
    v_cvt_pk_bf16_f32 v66, v174, v175
    v_cvt_pk_bf16_f32 v67, v206, v207
    s_nop 0
    v_lshlrev_b32 v60, 16, v66
    v_and_b32 v61, 0xffff0000, v66
    v_lshlrev_b32 v62, 16, v67
    v_and_b32 v63, 0xffff0000, v67
    v_mul_f32 v64, s42, v62
    v_mul_f32 v65, s42, v63
    v_exp_f32 v64, v64
    v_exp_f32 v65, v65
    s_nop 0
    v_add_f32 v64, 1.0, v64
    v_add_f32 v65, 1.0, v65
    v_rcp_f32 v64, v64
    v_rcp_f32 v65, v65
    s_nop 0
    v_mul_f32 v62, v62, v64
    v_mul_f32 v63, v63, v65
    v_cvt_pk_bf16_f32 v66, v62, v63
    s_nop 0
    v_lshlrev_b32 v62, 16, v66
    v_and_b32 v63, 0xffff0000, v66
    v_mul_f32 v60, v60, v62
    v_mul_f32 v61, v61, v63
    v_cvt_pk_bf16_f32 v66, v60, v61
    s_nop 0
    v_lshlrev_b32 v60, 16, v66
    v_and_b32 v61, 0xffff0000, v66
    v_lshlrev_b32 v64, 16, v51
    v_and_b32 v65, 0xffff0000, v51
    v_add_f32 v60, v60, v64
    v_add_f32 v61, v61, v65
    v_cvt_pk_bf16_f32 v75, v60, v61
    s_add_u32 s41, s45, 32800
    s_nop 0
    buffer_store_dwordx2 v[74:75], v32, s[16:19], s41 offen
    v_cvt_pk_bf16_f32 v66, v176, v177
    v_cvt_pk_bf16_f32 v67, v208, v209
    s_nop 0
    v_lshlrev_b32 v60, 16, v66
    v_and_b32 v61, 0xffff0000, v66
    v_lshlrev_b32 v62, 16, v67
    v_and_b32 v63, 0xffff0000, v67
    v_mul_f32 v64, s42, v62
    v_mul_f32 v65, s42, v63
    v_exp_f32 v64, v64
    v_exp_f32 v65, v65
    s_nop 0
    v_add_f32 v64, 1.0, v64
    v_add_f32 v65, 1.0, v65
    v_rcp_f32 v64, v64
    v_rcp_f32 v65, v65
    s_nop 0
    v_mul_f32 v62, v62, v64
    v_mul_f32 v63, v63, v65
    v_cvt_pk_bf16_f32 v66, v62, v63
    s_nop 0
    v_lshlrev_b32 v62, 16, v66
    v_and_b32 v63, 0xffff0000, v66
    v_mul_f32 v60, v60, v62
    v_mul_f32 v61, v61, v63
    v_cvt_pk_bf16_f32 v66, v60, v61
    s_nop 0
    v_lshlrev_b32 v60, 16, v66
    v_and_b32 v61, 0xffff0000, v66
    v_lshlrev_b32 v64, 16, v52
    v_and_b32 v65, 0xffff0000, v52
    v_add_f32 v60, v60, v64
    v_add_f32 v61, v61, v65
    v_cvt_pk_bf16_f32 v76, v60, v61
    v_cvt_pk_bf16_f32 v66, v178, v179
    v_cvt_pk_bf16_f32 v67, v210, v211
    s_nop 0
    v_lshlrev_b32 v60, 16, v66
    v_and_b32 v61, 0xffff0000, v66
    v_lshlrev_b32 v62, 16, v67
    v_and_b32 v63, 0xffff0000, v67
    v_mul_f32 v64, s42, v62
    v_mul_f32 v65, s42, v63
    v_exp_f32 v64, v64
    v_exp_f32 v65, v65
    s_nop 0
    v_add_f32 v64, 1.0, v64
    v_add_f32 v65, 1.0, v65
    v_rcp_f32 v64, v64
    v_rcp_f32 v65, v65
    s_nop 0
    v_mul_f32 v62, v62, v64
    v_mul_f32 v63, v63, v65
    v_cvt_pk_bf16_f32 v66, v62, v63
    s_nop 0
    v_lshlrev_b32 v62, 16, v66
    v_and_b32 v63, 0xffff0000, v66
    v_mul_f32 v60, v60, v62
    v_mul_f32 v61, v61, v63
    v_cvt_pk_bf16_f32 v66, v60, v61
    s_nop 0
    v_lshlrev_b32 v60, 16, v66
    v_and_b32 v61, 0xffff0000, v66
    v_lshlrev_b32 v64, 16, v53
    v_and_b32 v65, 0xffff0000, v53
    v_add_f32 v60, v60, v64
    v_add_f32 v61, v61, v65
    v_cvt_pk_bf16_f32 v77, v60, v61
    s_add_u32 s41, s45, 32832
    s_nop 0
    buffer_store_dwordx2 v[76:77], v32, s[16:19], s41 offen
    v_cvt_pk_bf16_f32 v66, v180, v181
    v_cvt_pk_bf16_f32 v67, v212, v213
    s_nop 0
    v_lshlrev_b32 v60, 16, v66
    v_and_b32 v61, 0xffff0000, v66
    v_lshlrev_b32 v62, 16, v67
    v_and_b32 v63, 0xffff0000, v67
    v_mul_f32 v64, s42, v62
    v_mul_f32 v65, s42, v63
    v_exp_f32 v64, v64
    v_exp_f32 v65, v65
    s_nop 0
    v_add_f32 v64, 1.0, v64
    v_add_f32 v65, 1.0, v65
    v_rcp_f32 v64, v64
    v_rcp_f32 v65, v65
    s_nop 0
    v_mul_f32 v62, v62, v64
    v_mul_f32 v63, v63, v65
    v_cvt_pk_bf16_f32 v66, v62, v63
    s_nop 0
    v_lshlrev_b32 v62, 16, v66
    v_and_b32 v63, 0xffff0000, v66
    v_mul_f32 v60, v60, v62
    v_mul_f32 v61, v61, v63
    v_cvt_pk_bf16_f32 v66, v60, v61
    s_nop 0
    v_lshlrev_b32 v60, 16, v66
    v_and_b32 v61, 0xffff0000, v66
    v_lshlrev_b32 v64, 16, v54
    v_and_b32 v65, 0xffff0000, v54
    v_add_f32 v60, v60, v64
    v_add_f32 v61, v61, v65
    v_cvt_pk_bf16_f32 v78, v60, v61
    v_cvt_pk_bf16_f32 v66, v182, v183
    v_cvt_pk_bf16_f32 v67, v214, v215
    s_nop 0
    v_lshlrev_b32 v60, 16, v66
    v_and_b32 v61, 0xffff0000, v66
    v_lshlrev_b32 v62, 16, v67
    v_and_b32 v63, 0xffff0000, v67
    v_mul_f32 v64, s42, v62
    v_mul_f32 v65, s42, v63
    v_exp_f32 v64, v64
    v_exp_f32 v65, v65
    s_nop 0
    v_add_f32 v64, 1.0, v64
    v_add_f32 v65, 1.0, v65
    v_rcp_f32 v64, v64
    v_rcp_f32 v65, v65
    s_nop 0
    v_mul_f32 v62, v62, v64
    v_mul_f32 v63, v63, v65
    v_cvt_pk_bf16_f32 v66, v62, v63
    s_nop 0
    v_lshlrev_b32 v62, 16, v66
    v_and_b32 v63, 0xffff0000, v66
    v_mul_f32 v60, v60, v62
    v_mul_f32 v61, v61, v63
    v_cvt_pk_bf16_f32 v66, v60, v61
    s_nop 0
    v_lshlrev_b32 v60, 16, v66
    v_and_b32 v61, 0xffff0000, v66
    v_lshlrev_b32 v64, 16, v55
    v_and_b32 v65, 0xffff0000, v55
    v_add_f32 v60, v60, v64
    v_add_f32 v61, v61, v65
    v_cvt_pk_bf16_f32 v79, v60, v61
    s_add_u32 s41, s45, 32864
    s_nop 0
    buffer_store_dwordx2 v[78:79], v32, s[16:19], s41 offen
g2_done:
    s_endpgm
.section .rodata,"a"
.p2align 6
.amdhsa_kernel ln_kernel
  .amdhsa_next_free_vgpr 48
  .amdhsa_next_free_sgpr 32
  .amdhsa_accum_offset 48
  .amdhsa_group_segment_fixed_size 0
  .amdhsa_kernarg_size 80
  .amdhsa_user_sgpr_count 2
  .amdhsa_user_sgpr_kernarg_segment_ptr 1
  .amdhsa_system_sgpr_workgroup_id_x 1
.end_amdhsa_kernel
.p2align 6
.amdhsa_kernel g1_kernel
  .amdhsa_next_free_vgpr 256
  .amdhsa_next_free_sgpr 100
  .amdhsa_accum_offset 256
  .amdhsa_group_segment_fixed_size 0
  .amdhsa_kernarg_size 80
  .amdhsa_user_sgpr_count 2
  .amdhsa_user_sgpr_kernarg_segment_ptr 1
  .amdhsa_system_sgpr_workgroup_id_x 1
.end_amdhsa_kernel
.p2align 6
.amdhsa_kernel attn_kernel
  .amdhsa_next_free_vgpr 104
  .amdhsa_next_free_sgpr 32
  .amdhsa_accum_offset 104
  .amdhsa_group_segment_fixed_size 0
  .amdhsa_kernarg_size 80
  .amdhsa_user_sgpr_count 2
  .amdhsa_user_sgpr_kernarg_segment_ptr 1
  .amdhsa_system_sgpr_workgroup_id_x 1
.end_amdhsa_kernel
.p2align 6
.amdhsa_kernel g2_kernel
  .amdhsa_next_free_vgpr 216
  .amdhsa_next_free_sgpr 100
  .amdhsa_accum_offset 216
  .amdhsa_group_segment_fixed_size 0
  .amdhsa_kernarg_size 80
  .amdhsa_user_sgpr_count 2
  .amdhsa_user_sgpr_kernarg_segment_ptr 1
  .amdhsa_system_sgpr_workgroup_id_x 1
.end_amdhsa_kernel
```
